```python
import torch

def _softmax(x, axis=-1):
    return torch.softmax(x, dim=axis)

def _gelu(x):
    return torch.nn.functional.gelu(x, approximate='tanh')

def _silu(x):
    return torch.nn.functional.silu(x)

def _sigmoid(x):
    return torch.sigmoid(x)

def _layernorm(x, axis=-1, eps=1e-05):
    m = x.mean(dim=axis, keepdim=True)
    v = x.var(dim=axis, keepdim=True, unbiased=False)
    return (x - m) / torch.sqrt(v + eps)

def _scatter_add(tgt, idx, src, axis=0):
    return tgt.clone().index_add_(axis, idx, src)

def _segment_sum(src, seg, n):
    out = torch.zeros((n,) + src.shape[1:], dtype=src.dtype)
    return out.index_add_(0, seg, src)

def _pad(x, pw):
    flat = tuple((v for pair in reversed(pw) for v in pair))
    return torch.nn.functional.pad(x, flat)
kernel_name = 'adaLN_cond__sliding_block_cached__dense_activation_squared_relu__decode'

def setup_inputs():

    _w = lambda a: (lambda t: t.to(torch.bfloat16) if t.is_floating_point() else t)(torch.as_tensor(a))

    def _A_setup():
        B, Sq, D = (4, 1, 512)
        Hq, Hkv, Sk, Dh = (32, 8, 8192, 128)
        assert Hq % Hkv == 0, (Hq, Hkv)
        return {'x': _w((lambda *s: torch.randn(*s, dtype=torch.bfloat16) * 0.05)(B, Sq, D)), 'k_cache': _w((lambda *s: torch.randn(*s, dtype=torch.bfloat16) * 3.2)(B, Hkv, Sk, Dh)), 'v_cache': _w((lambda *s: torch.randn(*s, dtype=torch.bfloat16) * 0.4)(B, Hkv, Sk, Dh)), 'wq': _w((lambda *s: torch.randn(*s, dtype=torch.bfloat16) * 3.2)(D, Hq * Dh) * D ** (-0.5)), 'wo': _w((lambda *s: torch.randn(*s, dtype=torch.bfloat16) * 0.4)(Hq * Dh, D) * (Hq * Dh) ** (-0.5))}
    _A_in = _A_setup()

    def _B_setup():
        B, S, D, F = (4, 1, 512, 1792)
        return {'x': _w((lambda *s: torch.randn(*s, dtype=torch.bfloat16) * 0.05)(B, S, D)), 'w1': _w((lambda *s: torch.randn(*s, dtype=torch.bfloat16) * 0.05)(D, F)), 'b1': _w((lambda *s: torch.randn(*s, dtype=torch.bfloat16) * 0.4)(F)), 'w2': _w((lambda *s: torch.randn(*s, dtype=torch.bfloat16) * 0.05)(F, D)), 'b2': _w((lambda *s: torch.randn(*s, dtype=torch.bfloat16) * 3.2)(D))}
    _B_in = _B_setup()
    return {'A_x': _A_in['x'], 'A_k_cache': _A_in['k_cache'], 'A_v_cache': _A_in['v_cache'], 'A_wq': _A_in['wq'], 'A_wo': _A_in['wo'], 'B_x': _B_in['x'], 'B_w1': _B_in['w1'], 'B_b1': _B_in['b1'], 'B_w2': _B_in['w2'], 'B_b2': _B_in['b2'], 'c': _w((lambda *s: torch.randn(*s, dtype=torch.bfloat16) * 0.1)(4, 512) * 8.0), 'w_mod': _w((lambda *s: torch.randn(*s, dtype=torch.bfloat16) * 0.1)(512, 6 * 512) * 512 ** (-0.5) * 8.0)}

def reference(A_x, A_k_cache, A_v_cache, A_wq, A_wo, B_x, B_w1, B_b1, B_w2, B_b2, c, w_mod):

    def _A_ref(x, k_cache, v_cache, wq, wo):
        B, Sq, D = x.shape
        Hq, Dh = (32, 128)
        Hkv, Sk = (k_cache.shape[1], k_cache.shape[2])
        W = min(4096, max(256, Sk // 4))
        rep = Hq // Hkv
        q = (lambda x, *d: x.permute(*d))((x @ wq).reshape(B, Sq, Hq, Dh), 0, 2, 1, 3)
        k = (lambda x, n, axis: torch.repeat_interleave(x, n, dim=axis))(k_cache[:, :, Sk - W:, :], rep, axis=1)
        v = (lambda x, n, axis: torch.repeat_interleave(x, n, dim=axis))(v_cache[:, :, Sk - W:, :], rep, axis=1)
        scores = torch.einsum('bhqd,bhkd->bhqk', q, k) * Dh ** (-0.5)
        p = _softmax(scores, axis=-1)
        o = torch.einsum('bhqk,bhkd->bhqd', p, v)
        return (lambda x, *d: x.permute(*d))(o, 0, 2, 1, 3).reshape(B, Sq, Hq * Dh) @ wo

    def _B_ref(x, w1, b1, w2, b2):
        h = torch.einsum('bsd,df->bsf', x, w1) + b1
        zero = torch.zeros_like(h)
        r = torch.where(h > zero, h, zero)
        h = r * r
        out = torch.einsum('bsf,fd->bsd', h, w2) + b2
        return out
    x = A_x
    mod = (_silu(c) @ w_mod).reshape(c.shape[0], 6, 1, -1)
    sa, ca, ga, sb, cb, gb = (mod[:, 0].clone(), mod[:, 1].clone(), mod[:, 2].clone(), mod[:, 3].clone(), mod[:, 4].clone(), mod[:, 5].clone())
    h = _layernorm(x, axis=-1) * (1 + ca) + sa
    x = x + ga * _A_ref(h, A_k_cache, A_v_cache, A_wq, A_wo)
    h = _layernorm(x, axis=-1) * (1 + cb) + sb
    x = x + gb * _B_ref(h, B_w1, B_b1, B_w2, B_b2)
    return x
```

```asm
; @launch grid=(256,1,1) block=(1024,1,1) lds=130304
.amdgcn_target "amdgcn-amd-amdhsa--gfx950"
.text
.p2align 12
.fill 832, 4, 0xbf800000
.globl adaLN_cond__sliding_block_cached__dense_activation_squared_relu__decode_kernel
.p2align 8
.type adaLN_cond__sliding_block_cached__dense_activation_squared_relu__decode_kernel,@function
adaLN_cond__sliding_block_cached__dense_activation_squared_relu__decode_kernel:
    s_cmp_ge_u32 s2, 256
    s_cbranch_scc1 L_end
    s_load_dwordx16 s[16:31], s[0:1], 0
    s_load_dwordx8 s[32:39], s[0:1], 64
    s_load_dwordx4 s[40:43], s[0:1], 96
    s_load_dwordx2 s[44:45], s[0:1], 112
    v_lshrrev_b32 v1, 6, v0
    v_and_b32 v0, 63, v0
    v_readfirstlane_b32 s3, v1
    s_and_b32 s4, s2, 7
    s_lshr_b32 s5, s2, 3
    v_and_b32 v1, 15, v0
    v_lshrrev_b32 v2, 4, v0
    v_lshlrev_b32 v7, 4, v0
    s_sub_u32 s13, s5, 8
    s_cmp_ge_u32 s13, 4
    s_cbranch_scc1 L_nopre
    s_sub_u32 s14, s3, 9
    s_cmp_ge_u32 s14, 5
    s_cbranch_scc1 L_nopre
    s_getpc_b64 s[52:53]
L_pc:
    s_mov_b32 s54, L_codeend-L_pc
    s_mov_b32 s55, 0x20000
    s_lshl2_add_u32 s13, s14, s13
    s_lshl_b32 s13, s13, 10
    buffer_load_dwordx4 v[8:11], v7, s[52:55], s13 offen
L_nopre:
    s_mov_b32 s6, 0x05040100
    s_mov_b32 s7, 0x07060302
    s_sub_u32 s11, s5, 12
    s_and_b32 s10, s11, 3
    s_lshr_b32 s11, s11, 2
    v_mov_b32 v97, 108416
    v_mov_b32 v102, 0
    v_mov_b32 v124, 1
    v_lshlrev_b32 v104, 2, v0
    v_add_u32 v104, 108288, v104
    ds_write_b32 v104, v102
    ds_write_b32 v104, v102 offset:512
    ds_write_b32 v104, v102 offset:768
    s_waitcnt lgkmcnt(0)
    s_mov_b32 s48, s44
    s_mov_b32 s49, s45
    s_mov_b32 s50, 0x800000
    s_mov_b32 s51, 0x20000
    s_cmp_lt_u32 s5, 12
    s_cbranch_scc0 L_A
    s_load_dwordx2 s[46:47], s[44:45], 0
    s_cmp_lt_u32 s5, 8
    s_cbranch_scc1 L_G1
    s_branch L_G2
L_A:
    s_mul_i32 s12, s4, 5
    s_add_u32 s12, s12, s11
    s_cmp_eq_u32 s11, 4
    s_cselect_b32 s62, 12, 13
    s_cmp_lt_u32 s3, s62
    s_cbranch_scc1 L_As
    s_cmp_eq_u32 s3, 15
    s_cbranch_scc1 L_fin
    s_load_dwordx2 s[46:47], s[44:45], 0
    s_barrier
    s_branch L_Ahelp
L_As:
    s_mov_b32 s52, s18
    s_mov_b32 s53, s19
    s_mov_b32 s54, 0x4000000
    s_mov_b32 s55, 0x20000
    s_mov_b32 s56, s20
    s_mov_b32 s57, s21
    s_mov_b32 s58, 0x4000000
    s_mov_b32 s59, 0x20000
    s_lshl_b32 s13, s10, 3
    s_add_u32 s13, s13, s4
    s_lshl_b32 s13, s13, 21
    s_mul_i32 s15, s11, 104
    s_add_u32 s15, s15, s3
    s_lshl_b32 s15, s15, 10
    s_lshl_b32 s62, s62, 10
    s_add_u32 s13, s13, s15
    s_add_u32 s72, s13, 0x180000
    s_cmp_lg_u32 s3, 0
    s_cbranch_scc1 L_Aw
    s_mov_b64 exec, 1
    buffer_load_dword v8, v7, s[52:55], s72 offen nt
    buffer_load_dword v9, v7, s[56:59], s72 offen nt
    s_mov_b64 exec, -1
L_Aw:
    s_add_u32 s73, s72, s62
    s_add_u32 s74, s73, s62
    s_add_u32 s75, s74, s62
    s_add_u32 s76, s75, s62
    s_add_u32 s77, s76, s62
    s_add_u32 s78, s77, s62
    s_add_u32 s79, s78, s62
    v_lshlrev_b32 v3, 6, v2
    v_xor_b32 v3, v3, v7
    v_xor_b32 v4, 16, v3
    v_xor_b32 v5, 32, v3
    v_xor_b32 v6, 48, v3
    s_lshl_b32 s15, s3, 2
    s_add_u32 s15, s15, 108768
    v_mov_b32 v125, s15
    s_barrier
    s_cmp_le_u32 s3, 7
    s_cbranch_scc1 L_Agk_ok
    s_mov_b32 s14, 0
L_Agk:
    ds_read_b32 v100, v125 offset:0
    s_add_u32 s14, s14, 1
    s_cmp_gt_u32 s14, 4194304
    s_cbranch_scc1 L_end
    s_waitcnt lgkmcnt(0)
    v_readfirstlane_b32 s15, v100
    s_nop 0
    s_cmp_eq_u32 s15, 0
    s_cbranch_scc0 L_Agk_ok
    s_sleep 1
    s_branch L_Agk
L_Agk_ok:
    s_cmp_eq_u32 s3, 0
    s_cbranch_scc1 L_Atk_ok
    s_mov_b32 s14, 0
L_Atk:
    ds_read_b32 v100, v125 offset:316
    s_add_u32 s14, s14, 1
    s_cmp_gt_u32 s14, 4194304
    s_cbranch_scc1 L_end
    s_waitcnt lgkmcnt(0)
    v_readfirstlane_b32 s15, v100
    s_nop 0
    s_cmp_eq_u32 s15, 0
    s_cbranch_scc0 L_Atk_ok
    s_branch L_Atk
L_Atk_ok:
    s_lshl_b32 s15, s3, 13
    s_mov_b32 m0, s15
    s_add_u32 s15, s15, 1024
    buffer_load_dwordx4 v3, s[52:55], s72 offen nt lds
    s_mov_b32 m0, s15
    s_add_u32 s15, s15, 1024
    buffer_load_dwordx4 v4, s[52:55], s73 offen nt lds
    s_mov_b32 m0, s15
    s_add_u32 s15, s15, 1024
    buffer_load_dwordx4 v5, s[52:55], s74 offen nt lds
    s_mov_b32 m0, s15
    s_add_u32 s15, s15, 1024
    buffer_load_dwordx4 v6, s[52:55], s75 offen nt lds
    s_mov_b32 m0, s15
    s_add_u32 s15, s15, 1024
    buffer_load_dwordx4 v3, s[52:55], s76 offen nt lds
    ds_write_b32 v125, v124 offset:320
    s_mov_b32 m0, s15
    s_add_u32 s15, s15, 1024
    buffer_load_dwordx4 v4, s[52:55], s77 offen nt lds
    s_mov_b32 m0, s15
    s_add_u32 s15, s15, 1024
    buffer_load_dwordx4 v5, s[52:55], s78 offen nt lds
    s_mov_b32 m0, s15
    s_add_u32 s15, s15, 1024
    buffer_load_dwordx4 v6, s[52:55], s79 offen nt lds
    s_branch L_A2
L_G1:
    s_mov_b32 s52, s22
    s_mov_b32 s53, s23
    s_mov_b32 s54, 0x400000
    s_mov_b32 s55, 0x20000
    v_and_b32 v3, 1, v2
    v_lshlrev_b32 v3, 14, v3
    v_lshrrev_b32 v4, 1, v2
    v_lshl_add_u32 v3, v4, 18, v3
    v_lshl_add_u32 v3, v1, 3, v3
    s_lshr_b32 s14, s3, 1
    s_lshl_b32 s14, s14, 19
    s_and_b32 s15, s3, 1
    s_lshl_b32 s15, s15, 15
    s_add_u32 s14, s14, s15
    s_lshl_b32 s15, s4, 10
    s_add_u32 s14, s14, s15
    s_lshl_b32 s15, s5, 7
    s_add_u32 s14, s14, s15
    buffer_load_dwordx2 v[8:9], v3, s[52:55], s14 offen nt
    s_add_u32 s13, s14, 0x10000
    buffer_load_dwordx2 v[10:11], v3, s[52:55], s13 offen nt
    s_add_u32 s13, s14, 0x20000
    buffer_load_dwordx2 v[12:13], v3, s[52:55], s13 offen nt
    s_add_u32 s13, s14, 0x30000
    buffer_load_dwordx2 v[14:15], v3, s[52:55], s13 offen nt
    s_add_u32 s13, s14, 0x2000
    buffer_load_dwordx2 v[16:17], v3, s[52:55], s13 offen nt
    s_add_u32 s13, s14, 0x12000
    buffer_load_dwordx2 v[18:19], v3, s[52:55], s13 offen nt
    s_add_u32 s13, s14, 0x22000
    buffer_load_dwordx2 v[20:21], v3, s[52:55], s13 offen nt
    s_add_u32 s13, s14, 0x32000
    buffer_load_dwordx2 v[22:23], v3, s[52:55], s13 offen nt
    s_branch L_G1b
L_G2:
    s_sub_u32 s10, s5, 8
    s_lshl_b32 s12, s4, 1
    s_add_u32 s12, s12, 40
    s_mov_b32 s11, 7
    s_cmp_ge_u32 s3, 5
    s_cbranch_scc1 L_G2w
    s_cmp_eq_u32 s3, 4
    s_cbranch_scc1 L_G2H
    s_mov_b32 s52, s38
    s_mov_b32 s53, s39
    s_mov_b32 s54, 0x300000
    s_mov_b32 s55, 0x20000
    s_mov_b32 s56, s36
    s_mov_b32 s57, s37
    s_mov_b32 s58, 0x1000
    s_mov_b32 s59, 0x20000
    s_lshl2_add_u32 s60, s10, s3
    v_mul_u32_u24 v3, 49152, v2
    v_and_b32 v4, 7, v0
    v_lshl_add_u32 v3, v4, 4, v3
    v_bfe_u32 v4, v0, 3, 1
    v_lshl_add_u32 v3, v4, 10, v3
    s_mul_i32 s14, s60, 196608
    s_lshl_b32 s15, s4, 7
    s_add_u32 s14, s14, s15
    v_mov_b32 v72, 0
    v_mov_b32 v73, 0
    v_mov_b32 v74, 0
    v_mov_b32 v75, 0
    v_and_b32 v4, 3, v0
    v_lshlrev_b32 v4, 10, v4
    v_lshl_add_u32 v4, v2, 4, v4
    s_lshl_b32 s15, s60, 6
    s_mov_b32 exec_lo, 0xf000f
    s_mov_b32 exec_hi, 0xf000f
    buffer_load_dwordx4 v[72:75], v4, s[56:59], s15 offen
    s_mov_b64 exec, -1
    buffer_load_dwordx4 v[8:11], v3, s[52:55], s14 offen nt
    s_add_u32 s14, s14, 6144
    buffer_load_dwordx4 v[12:15], v3, s[52:55], s14 offen nt
    s_add_u32 s14, s14, 6144
    buffer_load_dwordx4 v[16:19], v3, s[52:55], s14 offen nt
    s_add_u32 s14, s14, 6144
    buffer_load_dwordx4 v[20:23], v3, s[52:55], s14 offen nt
    s_add_u32 s14, s14, 6144
    buffer_load_dwordx4 v[24:27], v3, s[52:55], s14 offen nt
    s_add_u32 s14, s14, 6144
    buffer_load_dwordx4 v[28:31], v3, s[52:55], s14 offen nt
    s_add_u32 s14, s14, 6144
    buffer_load_dwordx4 v[32:35], v3, s[52:55], s14 offen nt
    s_add_u32 s14, s14, 6144
    buffer_load_dwordx4 v[36:39], v3, s[52:55], s14 offen nt
    s_barrier
    v_mov_b32 v76, 0
    v_mov_b32 v77, 0
    v_mov_b32 v78, 0
    v_mov_b32 v79, 0
    v_mov_b32 v80, 0
    v_mov_b32 v81, 0
    v_mov_b32 v82, 0
    v_mov_b32 v83, 0
    v_mov_b32 v84, 0
    v_mov_b32 v85, 0
    v_mov_b32 v86, 0
    v_mov_b32 v87, 0
    s_waitcnt lgkmcnt(0)
    s_mul_i32 s8, s46, 1664525
    s_add_u32 s8, s8, 1013904223
    s_mul_i32 s9, s47, 22695477
    s_add_u32 s9, s9, 1
    s_lshl2_add_u32 s14, s4, s10
    s_lshl2_add_u32 s14, s14, s3
    s_lshl_b32 s14, s14, 10
    s_add_u32 s14, s14, 0x180000
    s_add_u32 s13, s14, 0x20000
    s_lshl_b32 s15, s3, 11
    v_add_u32 v118, s15, v7
    v_and_b32 v116, 1, v0
    v_lshlrev_b32 v116, 3, v116
    v_bfe_u32 v4, v0, 1, 3
    v_lshl_add_u32 v116, v4, 6, v116
    v_bfe_u32 v4, v0, 4, 1
    v_lshl_add_u32 v116, v4, 10, v116
    v_lshrrev_b32 v4, 5, v0
    v_lshl_add_u32 v116, v4, 9, v116
    s_lshl_b32 s15, s3, 4
    v_add_u32 v116, s15, v116
    v_mov_b32 v110, s8
    v_mov_b32 v111, s9
    s_waitcnt vmcnt(8)
    s_mov_b32 exec_lo, 0xf000f
    s_mov_b32 exec_hi, 0xf000f
    v_lshlrev_b32 v88, 16, v72
    v_and_b32 v89, 0xffff0000, v72
    v_mul_f32 v90, 0xbfb8aa3b, v88
    v_mul_f32 v91, 0xbfb8aa3b, v89
    v_exp_f32 v90, v90
    v_exp_f32 v91, v91
    v_add_f32 v90, 1.0, v90
    v_add_f32 v91, 1.0, v91
    v_rcp_f32 v90, v90
    v_rcp_f32 v91, v91
    v_mul_f32 v88, v88, v90
    v_mul_f32 v89, v89, v91
    v_cvt_pk_bf16_f32 v72, v88, v89
    v_lshlrev_b32 v88, 16, v73
    v_and_b32 v89, 0xffff0000, v73
    v_mul_f32 v90, 0xbfb8aa3b, v88
    v_mul_f32 v91, 0xbfb8aa3b, v89
    v_exp_f32 v90, v90
    v_exp_f32 v91, v91
    v_add_f32 v90, 1.0, v90
    v_add_f32 v91, 1.0, v91
    v_rcp_f32 v90, v90
    v_rcp_f32 v91, v91
    v_mul_f32 v88, v88, v90
    v_mul_f32 v89, v89, v91
    v_cvt_pk_bf16_f32 v73, v88, v89
    v_lshlrev_b32 v88, 16, v74
    v_and_b32 v89, 0xffff0000, v74
    v_mul_f32 v90, 0xbfb8aa3b, v88
    v_mul_f32 v91, 0xbfb8aa3b, v89
    v_exp_f32 v90, v90
    v_exp_f32 v91, v91
    v_add_f32 v90, 1.0, v90
    v_add_f32 v91, 1.0, v91
    v_rcp_f32 v90, v90
    v_rcp_f32 v91, v91
    v_mul_f32 v88, v88, v90
    v_mul_f32 v89, v89, v91
    v_cvt_pk_bf16_f32 v74, v88, v89
    v_lshlrev_b32 v88, 16, v75
    v_and_b32 v89, 0xffff0000, v75
    v_mul_f32 v90, 0xbfb8aa3b, v88
    v_mul_f32 v91, 0xbfb8aa3b, v89
    v_exp_f32 v90, v90
    v_exp_f32 v91, v91
    v_add_f32 v90, 1.0, v90
    v_add_f32 v91, 1.0, v91
    v_rcp_f32 v90, v90
    v_rcp_f32 v91, v91
    v_mul_f32 v88, v88, v90
    v_mul_f32 v89, v89, v91
    v_cvt_pk_bf16_f32 v75, v88, v89
    s_mov_b64 exec, -1
    v_mov_b32_dpp v76, v72 row_ror:4 row_mask:0xf bank_mask:0x2
    v_mov_b32_dpp v77, v73 row_ror:4 row_mask:0xf bank_mask:0x2
    v_mov_b32_dpp v78, v74 row_ror:4 row_mask:0xf bank_mask:0x2
    v_mov_b32_dpp v79, v75 row_ror:4 row_mask:0xf bank_mask:0x2
    v_mov_b32_dpp v80, v72 row_ror:8 row_mask:0xf bank_mask:0x4
    v_mov_b32_dpp v81, v73 row_ror:8 row_mask:0xf bank_mask:0x4
    v_mov_b32_dpp v82, v74 row_ror:8 row_mask:0xf bank_mask:0x4
    v_mov_b32_dpp v83, v75 row_ror:8 row_mask:0xf bank_mask:0x4
    v_mov_b32_dpp v84, v72 row_ror:12 row_mask:0xf bank_mask:0x8
    v_mov_b32_dpp v85, v73 row_ror:12 row_mask:0xf bank_mask:0x8
    v_mov_b32_dpp v86, v74 row_ror:12 row_mask:0xf bank_mask:0x8
    v_mov_b32_dpp v87, v75 row_ror:12 row_mask:0xf bank_mask:0x8
    s_waitcnt vmcnt(6)
    v_perm_b32 v40, v12, v8, s6
    v_perm_b32 v44, v12, v8, s7
    v_perm_b32 v48, v13, v9, s6
    v_perm_b32 v52, v13, v9, s7
    v_perm_b32 v56, v14, v10, s6
    v_perm_b32 v60, v14, v10, s7
    v_perm_b32 v64, v15, v11, s6
    v_perm_b32 v68, v15, v11, s7
    s_waitcnt vmcnt(4)
    v_perm_b32 v41, v20, v16, s6
    v_perm_b32 v45, v20, v16, s7
    v_perm_b32 v49, v21, v17, s6
    v_perm_b32 v53, v21, v17, s7
    v_perm_b32 v57, v22, v18, s6
    v_perm_b32 v61, v22, v18, s7
    v_perm_b32 v65, v23, v19, s6
    v_perm_b32 v69, v23, v19, s7
    s_waitcnt vmcnt(2)
    v_perm_b32 v42, v28, v24, s6
    v_perm_b32 v46, v28, v24, s7
    v_perm_b32 v50, v29, v25, s6
    v_perm_b32 v54, v29, v25, s7
    v_perm_b32 v58, v30, v26, s6
    v_perm_b32 v62, v30, v26, s7
    v_perm_b32 v66, v31, v27, s6
    v_perm_b32 v70, v31, v27, s7
    s_waitcnt vmcnt(0)
    v_perm_b32 v43, v36, v32, s6
    v_perm_b32 v47, v36, v32, s7
    v_perm_b32 v51, v37, v33, s6
    v_perm_b32 v55, v37, v33, s7
    v_perm_b32 v59, v38, v34, s6
    v_perm_b32 v63, v38, v34, s7
    v_perm_b32 v67, v39, v35, s6
    v_perm_b32 v71, v39, v35, s7
    v_mfma_f32_16x16x32_bf16 v[88:91], v[40:43], v[72:75], 0
    v_mfma_f32_16x16x32_bf16 v[92:95], v[56:59], v[72:75], 0
    v_mfma_f32_16x16x32_bf16 v[88:91], v[44:47], v[76:79], v[88:91]
    v_mfma_f32_16x16x32_bf16 v[92:95], v[60:63], v[76:79], v[92:95]
    v_mfma_f32_16x16x32_bf16 v[88:91], v[48:51], v[80:83], v[88:91]
    v_mfma_f32_16x16x32_bf16 v[92:95], v[64:67], v[80:83], v[92:95]
    v_mfma_f32_16x16x32_bf16 v[88:91], v[52:55], v[84:87], v[88:91]
    v_mfma_f32_16x16x32_bf16 v[92:95], v[68:71], v[84:87], v[92:95]
    s_nop 6
    ds_write_b128 v118, v[88:91] offset:0
    ds_write_b128 v118, v[92:95] offset:1024
    s_waitcnt lgkmcnt(0)
    s_barrier
    ds_read_b64 v[8:9], v116 offset:0
    ds_read_b64 v[10:11], v116 offset:2048
    ds_read_b64 v[12:13], v116 offset:4096
    ds_read_b64 v[14:15], v116 offset:6144
    s_waitcnt lgkmcnt(0)
    v_pk_add_f32 v[8:9], v[8:9], v[10:11]
    v_pk_add_f32 v[12:13], v[12:13], v[14:15]
    v_pk_add_f32 v[108:109], v[8:9], v[12:13]
    buffer_store_dwordx4 v[108:111], v7, s[48:51], s14 offen
    s_mov_b32 s14, 0
L_G2c:
    ds_read_b32 v4, v97
    s_add_u32 s14, s14, 1
    s_sleep 4
    s_waitcnt lgkmcnt(0)
    v_readfirstlane_b32 s15, v4
    s_cmp_ge_u32 s14, 12
    s_cselect_b32 s15, 1, s15
    s_cmp_eq_u32 s15, 0
    s_cbranch_scc1 L_G2c
    buffer_store_dwordx4 v[108:111], v7, s[48:51], s13 offen sc1
    s_branch L_G2MR
L_G2w:
    s_barrier
    s_waitcnt lgkmcnt(0)
    s_mul_i32 s8, s46, 1664525
    s_add_u32 s8, s8, 1013904223
    s_mul_i32 s9, s47, 22695477
    s_add_u32 s9, s9, 1
    s_barrier
    s_branch L_G2MR
L_G2H:
    s_mov_b32 s52, s16
    s_mov_b32 s53, s17
    s_mov_b32 s54, 0x1000
    s_mov_b32 s55, 0x20000
    s_lshl_b32 s15, s10, 10
    buffer_load_dwordx4 v[40:43], v7, s[52:55], s15 offen
    v_bfe_u32 v4, v0, 1, 2
    v_bfe_u32 v5, v0, 4, 1
    v_lshl_add_u32 v4, v5, 2, v4
    v_and_b32 v5, 1, v0
    v_lshl_add_u32 v4, v5, 4, v4
    v_bfe_u32 v5, v0, 3, 1
    v_lshl_add_u32 v4, v5, 5, v4
    v_lshlrev_b32 v4, 1, v4
    s_lshl_b32 s14, s4, 7
    s_add_u32 s15, s15, s14
    s_barrier
    buffer_load_ushort v44, v4, s[52:55], s15 offen
    buffer_load_ushort v45, v4, s[52:55], s15 offen offset:16
    v_mov_b32 v112, -1
    v_mov_b32 v113, -1
    v_mov_b32 v114, -1
    v_mov_b32 v115, -1
    s_lshl2_add_u32 s60, s4, s10
    s_lshl_b32 s15, s60, 11
    s_add_u32 s15, s15, 0x20000
    buffer_store_dwordx4 v[112:115], v7, s[48:51], s15 offen offset:0 sc1
    buffer_store_dwordx4 v[112:115], v7, s[48:51], s15 offen offset:1024 sc1
    s_lshr_b32 s15, s60, 3
    s_lshl_b32 s15, s15, 14
    s_and_b32 s13, s60, 1
    s_lshl_b32 s13, s13, 11
    s_add_u32 s15, s15, s13
    s_bfe_u32 s13, s60, 0x20001
    s_lshl_b32 s13, s13, 9
    s_add_u32 s15, s15, s13
    s_add_u32 s15, s15, 0x10000
    s_add_u32 s14, s15, 8192
    v_and_b32 v5, 31, v0
    v_lshlrev_b32 v5, 4, v5
    v_lshrrev_b32 v6, 5, v0
    v_lshl_add_u32 v5, v6, 12, v5
    buffer_store_dwordx4 v[112:115], v5, s[48:51], s15 offen sc1
    buffer_store_dwordx4 v[112:115], v5, s[48:51], s14 offen sc1
    s_lshl_b32 s14, s4, 14
    s_lshl_b32 s15, s10, 10
    s_add_u32 s14, s14, s15
    s_add_u32 s80, s14, 0x180000
    s_add_u32 s81, s80, 4096
    s_add_u32 s82, s80, 8192
    s_add_u32 s83, s80, 12288
    buffer_load_dwordx4 v[8:11], v7, s[48:51], s80 offen sc1
    buffer_load_dwordx4 v[12:15], v7, s[48:51], s81 offen sc1
    buffer_load_dwordx4 v[16:19], v7, s[48:51], s82 offen sc1
    buffer_load_dwordx4 v[20:23], v7, s[48:51], s83 offen sc1
    v_lshlrev_b32 v6, 3, v0
    s_lshl_b32 s60, s60, 8
    s_add_u32 s60, s60, 0x1c0000
    s_waitcnt lgkmcnt(0)
    s_mul_i32 s8, s46, 1664525
    s_add_u32 s8, s8, 1013904223
    s_mul_i32 s9, s47, 22695477
    s_add_u32 s9, s9, 1
    v_mov_b32 v62, s8
    v_mov_b32 v63, s9
    s_waitcnt vmcnt(8)
    v_lshlrev_b32 v48, 16, v40
    v_and_b32 v49, 0xffff0000, v40
    v_lshlrev_b32 v50, 16, v41
    v_and_b32 v51, 0xffff0000, v41
    v_lshlrev_b32 v52, 16, v42
    v_and_b32 v53, 0xffff0000, v42
    v_lshlrev_b32 v54, 16, v43
    v_and_b32 v55, 0xffff0000, v43
    v_add_f32 v46, v48, v49
    v_add_f32 v46, v46, v50
    v_add_f32 v46, v46, v51
    v_add_f32 v46, v46, v52
    v_add_f32 v46, v46, v53
    v_add_f32 v46, v46, v54
    v_add_f32 v46, v46, v55
    s_nop 1
    v_add_f32_dpp v46, v46, v46 quad_perm:[1,0,3,2] row_mask:0xf bank_mask:0xf
    s_nop 1
    v_add_f32_dpp v46, v46, v46 quad_perm:[2,3,0,1] row_mask:0xf bank_mask:0xf
    s_nop 1
    v_add_f32_dpp v46, v46, v46 row_half_mirror row_mask:0xf bank_mask:0xf
    s_nop 1
    v_add_f32_dpp v46, v46, v46 row_mirror row_mask:0xf bank_mask:0xf
    v_mov_b32 v47, v46
    s_nop 1
    v_permlane16_swap_b32 v46, v47
    v_add_f32 v46, v46, v47
    v_mov_b32 v47, v46
    s_nop 1
    v_permlane32_swap_b32 v46, v47
    v_add_f32 v46, v46, v47
    v_mul_f32 v46, 0x3b000000, v46
    v_sub_f32 v48, v48, v46
    v_sub_f32 v49, v49, v46
    v_sub_f32 v50, v50, v46
    v_sub_f32 v51, v51, v46
    v_sub_f32 v52, v52, v46
    v_sub_f32 v53, v53, v46
    v_sub_f32 v54, v54, v46
    v_sub_f32 v55, v55, v46
    v_mul_f32 v47, v48, v48
    v_fmac_f32 v47, v49, v49
    v_fmac_f32 v47, v50, v50
    v_fmac_f32 v47, v51, v51
    v_fmac_f32 v47, v52, v52
    v_fmac_f32 v47, v53, v53
    v_fmac_f32 v47, v54, v54
    v_fmac_f32 v47, v55, v55
    s_nop 1
    v_add_f32_dpp v47, v47, v47 quad_perm:[1,0,3,2] row_mask:0xf bank_mask:0xf
    s_nop 1
    v_add_f32_dpp v47, v47, v47 quad_perm:[2,3,0,1] row_mask:0xf bank_mask:0xf
    s_nop 1
    v_add_f32_dpp v47, v47, v47 row_half_mirror row_mask:0xf bank_mask:0xf
    s_nop 1
    v_add_f32_dpp v47, v47, v47 row_mirror row_mask:0xf bank_mask:0xf
    v_mov_b32 v48, v47
    s_nop 1
    v_permlane16_swap_b32 v47, v48
    v_add_f32 v47, v47, v48
    v_mov_b32 v48, v47
    s_nop 1
    v_permlane32_swap_b32 v47, v48
    v_add_f32 v47, v47, v48
    v_mul_f32 v47, 0x3b000000, v47
    v_cvt_pk_bf16_f32 v48, v46, v47
    v_lshlrev_b32 v46, 16, v48
    v_and_b32 v47, 0xffff0000, v48
    v_add_f32 v47, 0x3727c5ac, v47
    v_cvt_pk_bf16_f32 v47, v47, v47
    v_lshlrev_b32 v47, 16, v47
    v_sqrt_f32 v47, v47
    s_nop 0
    v_cvt_pk_bf16_f32 v47, v47, v47
    v_lshlrev_b32 v47, 16, v47
    v_rcp_f32 v47, v47
    v_lshlrev_b32 v44, 16, v44
    v_lshlrev_b32 v45, 16, v45
    v_sub_f32 v44, v44, v46
    v_sub_f32 v45, v45, v46
    v_cvt_pk_bf16_f32 v48, v44, v45
    v_lshlrev_b32 v44, 16, v48
    v_and_b32 v45, 0xffff0000, v48
    v_mul_f32 v44, v44, v47
    v_mul_f32 v45, v45, v47
    v_cvt_pk_bf16_f32 v48, v44, v45
    v_lshlrev_b32 v44, 16, v48
    v_and_b32 v45, 0xffff0000, v48
    s_barrier
    s_mov_b32 s14, 0
    s_mov_b64 s[64:65], -1
    s_mov_b64 s[66:67], -1
    s_mov_b64 s[68:69], -1
    s_mov_b64 s[70:71], -1
L_poll_1:
    s_cmp_ge_u32 s14, 16
    s_cselect_b32 s15, 0x20000, 0
    s_xor_b32 s80, s80, s15
    s_xor_b32 s81, s81, s15
    s_xor_b32 s82, s82, s15
    s_xor_b32 s83, s83, s15
    s_mov_b64 exec, s[64:65]
    buffer_load_dwordx4 v[8:11], v7, s[48:51], s80 offen sc1
    s_mov_b64 exec, s[66:67]
    buffer_load_dwordx4 v[12:15], v7, s[48:51], s81 offen sc1
    s_mov_b64 exec, s[68:69]
    buffer_load_dwordx4 v[16:19], v7, s[48:51], s82 offen sc1
    s_mov_b64 exec, s[70:71]
    buffer_load_dwordx4 v[20:23], v7, s[48:51], s83 offen sc1
    s_add_u32 s14, s14, 1
    s_cmp_gt_u32 s14, 1048576
    s_cbranch_scc1 L_end
    s_waitcnt vmcnt(3)
    s_mov_b64 exec, s[64:65]
    v_cmp_ne_u64 s[64:65], s[8:9], v[10:11]
    s_waitcnt vmcnt(2)
    s_mov_b64 exec, s[66:67]
    v_cmp_ne_u64 s[66:67], s[8:9], v[14:15]
    s_waitcnt vmcnt(1)
    s_mov_b64 exec, s[68:69]
    v_cmp_ne_u64 s[68:69], s[8:9], v[18:19]
    s_waitcnt vmcnt(0)
    s_mov_b64 exec, s[70:71]
    v_cmp_ne_u64 s[70:71], s[8:9], v[22:23]
    s_or_b64 s[46:47], s[64:65], s[66:67]
    s_or_b64 s[46:47], s[46:47], s[68:69]
    s_or_b64 s[46:47], s[46:47], s[70:71]
    s_cbranch_scc1 L_poll_1
    s_mov_b64 exec, -1
    v_pk_add_f32 v[8:9], v[8:9], v[12:13]
    v_pk_add_f32 v[16:17], v[16:17], v[20:21]
    v_pk_add_f32 v[8:9], v[8:9], v[16:17]
    v_cvt_pk_bf16_f32 v8, v8, v9
    v_mov_b32 v9, v8
    s_nop 1
    v_permlane32_swap_b32 v8, v9
    v_lshlrev_b32 v10, 16, v8
    v_and_b32 v11, 0xffff0000, v8
    v_lshlrev_b32 v12, 16, v9
    v_and_b32 v13, 0xffff0000, v9
    v_add_f32 v12, 1.0, v12
    v_add_f32 v13, 1.0, v13
    v_cvt_pk_bf16_f32 v14, v12, v13
    v_lshlrev_b32 v12, 16, v14
    v_and_b32 v13, 0xffff0000, v14
    v_mul_f32 v12, v44, v12
    v_mul_f32 v13, v45, v13
    v_cvt_pk_bf16_f32 v14, v12, v13
    v_lshlrev_b32 v12, 16, v14
    v_and_b32 v13, 0xffff0000, v14
    v_add_f32 v12, v12, v10
    v_add_f32 v13, v13, v11
    v_cvt_pk_bf16_f32 v60, v12, v13
    s_nop 1
    v_mov_b32_dpp v61, v60 quad_perm:[1,0,3,2] row_mask:0xf bank_mask:0xf
    s_mov_b32 exec_lo, 0x55555555
    s_mov_b32 exec_hi, 0x0
    buffer_store_dwordx4 v[60:63], v6, s[48:51], s60 offen sc1
    s_mov_b64 exec, -1
    ds_write_b32 v97, v124
L_G2MR:
    s_mov_b32 s88, s3
    s_lshl2_add_u32 s3, s10, s3
    s_and_b32 s3, s3, 15
    s_cmp_lt_u32 s88, 8
    s_cbranch_scc1 L_G2m
    s_barrier
    s_barrier
    s_branch L_Fld
L_G2m:
    s_mov_b32 s52, s38
    s_mov_b32 s53, s39
    s_mov_b32 s54, 0x300000
    s_mov_b32 s55, 0x20000
    s_mov_b32 s56, s36
    s_mov_b32 s57, s37
    s_mov_b32 s58, 0x1000
    s_mov_b32 s59, 0x20000
    s_lshl2_add_u32 s90, s4, s10
    s_and_b32 s15, s90, 1
    s_lshl_b32 s15, s15, 3
    s_add_u32 s15, s15, s88
    s_mul_i32 s14, s15, 196608
    s_lshl_b32 s15, s15, 6
    s_lshr_b32 s13, s90, 1
    s_lshl_b32 s13, s13, 8
    s_add_u32 s14, s14, s13
    s_add_u32 s14, s14, 2048
    v_and_b32 v4, 3, v0
    v_lshlrev_b32 v4, 10, v4
    v_lshl_add_u32 v4, v2, 4, v4
    v_mul_u32_u24 v3, 49152, v2
    v_lshl_add_u32 v3, v1, 4, v3
    v_mov_b32 v72, 0
    v_mov_b32 v73, 0
    v_mov_b32 v74, 0
    v_mov_b32 v75, 0
    v_mov_b32 v76, 0
    v_mov_b32 v77, 0
    v_mov_b32 v78, 0
    v_mov_b32 v79, 0
    v_mov_b32 v80, 0
    v_mov_b32 v81, 0
    v_mov_b32 v82, 0
    v_mov_b32 v83, 0
    v_mov_b32 v84, 0
    v_mov_b32 v85, 0
    v_mov_b32 v86, 0
    v_mov_b32 v87, 0
    s_barrier
    s_mov_b32 exec_lo, 0xf000f
    s_mov_b32 exec_hi, 0xf000f
    buffer_load_dwordx4 v[72:75], v4, s[56:59], s15 offen
    s_mov_b64 exec, -1
    buffer_load_dwordx4 v[8:11], v3, s[52:55], s14 offen nt
    s_add_u32 s14, s14, 6144
    buffer_load_dwordx4 v[12:15], v3, s[52:55], s14 offen nt
    s_add_u32 s14, s14, 6144
    buffer_load_dwordx4 v[16:19], v3, s[52:55], s14 offen nt
    s_add_u32 s14, s14, 6144
    buffer_load_dwordx4 v[20:23], v3, s[52:55], s14 offen nt
    s_add_u32 s14, s14, 6144
    buffer_load_dwordx4 v[24:27], v3, s[52:55], s14 offen nt
    s_add_u32 s14, s14, 6144
    buffer_load_dwordx4 v[28:31], v3, s[52:55], s14 offen nt
    s_add_u32 s14, s14, 6144
    buffer_load_dwordx4 v[32:35], v3, s[52:55], s14 offen nt
    s_add_u32 s14, s14, 6144
    buffer_load_dwordx4 v[36:39], v3, s[52:55], s14 offen nt
    s_barrier
    s_lshl_b32 s15, s88, 11
    v_add_u32 v118, s15, v7
    s_waitcnt vmcnt(8)
    s_mov_b32 exec_lo, 0xf000f
    s_mov_b32 exec_hi, 0xf000f
    v_lshlrev_b32 v88, 16, v72
    v_and_b32 v89, 0xffff0000, v72
    v_mul_f32 v90, 0xbfb8aa3b, v88
    v_mul_f32 v91, 0xbfb8aa3b, v89
    v_exp_f32 v90, v90
    v_exp_f32 v91, v91
    v_add_f32 v90, 1.0, v90
    v_add_f32 v91, 1.0, v91
    v_rcp_f32 v90, v90
    v_rcp_f32 v91, v91
    v_mul_f32 v88, v88, v90
    v_mul_f32 v89, v89, v91
    v_cvt_pk_bf16_f32 v72, v88, v89
    v_lshlrev_b32 v88, 16, v73
    v_and_b32 v89, 0xffff0000, v73
    v_mul_f32 v90, 0xbfb8aa3b, v88
    v_mul_f32 v91, 0xbfb8aa3b, v89
    v_exp_f32 v90, v90
    v_exp_f32 v91, v91
    v_add_f32 v90, 1.0, v90
    v_add_f32 v91, 1.0, v91
    v_rcp_f32 v90, v90
    v_rcp_f32 v91, v91
    v_mul_f32 v88, v88, v90
    v_mul_f32 v89, v89, v91
    v_cvt_pk_bf16_f32 v73, v88, v89
    v_lshlrev_b32 v88, 16, v74
    v_and_b32 v89, 0xffff0000, v74
    v_mul_f32 v90, 0xbfb8aa3b, v88
    v_mul_f32 v91, 0xbfb8aa3b, v89
    v_exp_f32 v90, v90
    v_exp_f32 v91, v91
    v_add_f32 v90, 1.0, v90
    v_add_f32 v91, 1.0, v91
    v_rcp_f32 v90, v90
    v_rcp_f32 v91, v91
    v_mul_f32 v88, v88, v90
    v_mul_f32 v89, v89, v91
    v_cvt_pk_bf16_f32 v74, v88, v89
    v_lshlrev_b32 v88, 16, v75
    v_and_b32 v89, 0xffff0000, v75
    v_mul_f32 v90, 0xbfb8aa3b, v88
    v_mul_f32 v91, 0xbfb8aa3b, v89
    v_exp_f32 v90, v90
    v_exp_f32 v91, v91
    v_add_f32 v90, 1.0, v90
    v_add_f32 v91, 1.0, v91
    v_rcp_f32 v90, v90
    v_rcp_f32 v91, v91
    v_mul_f32 v88, v88, v90
    v_mul_f32 v89, v89, v91
    v_cvt_pk_bf16_f32 v75, v88, v89
    s_mov_b64 exec, -1
    v_mov_b32_dpp v76, v72 row_ror:4 row_mask:0xf bank_mask:0x2
    v_mov_b32_dpp v77, v73 row_ror:4 row_mask:0xf bank_mask:0x2
    v_mov_b32_dpp v78, v74 row_ror:4 row_mask:0xf bank_mask:0x2
    v_mov_b32_dpp v79, v75 row_ror:4 row_mask:0xf bank_mask:0x2
    v_mov_b32_dpp v80, v72 row_ror:8 row_mask:0xf bank_mask:0x4
    v_mov_b32_dpp v81, v73 row_ror:8 row_mask:0xf bank_mask:0x4
    v_mov_b32_dpp v82, v74 row_ror:8 row_mask:0xf bank_mask:0x4
    v_mov_b32_dpp v83, v75 row_ror:8 row_mask:0xf bank_mask:0x4
    v_mov_b32_dpp v84, v72 row_ror:12 row_mask:0xf bank_mask:0x8
    v_mov_b32_dpp v85, v73 row_ror:12 row_mask:0xf bank_mask:0x8
    v_mov_b32_dpp v86, v74 row_ror:12 row_mask:0xf bank_mask:0x8
    v_mov_b32_dpp v87, v75 row_ror:12 row_mask:0xf bank_mask:0x8
    s_waitcnt vmcnt(6)
    v_perm_b32 v40, v12, v8, s6
    v_perm_b32 v44, v12, v8, s7
    v_perm_b32 v48, v13, v9, s6
    v_perm_b32 v52, v13, v9, s7
    v_perm_b32 v56, v14, v10, s6
    v_perm_b32 v60, v14, v10, s7
    v_perm_b32 v64, v15, v11, s6
    v_perm_b32 v68, v15, v11, s7
    s_waitcnt vmcnt(4)
    v_perm_b32 v41, v20, v16, s6
    v_perm_b32 v45, v20, v16, s7
    v_perm_b32 v49, v21, v17, s6
    v_perm_b32 v53, v21, v17, s7
    v_perm_b32 v57, v22, v18, s6
    v_perm_b32 v61, v22, v18, s7
    v_perm_b32 v65, v23, v19, s6
    v_perm_b32 v69, v23, v19, s7
    s_waitcnt vmcnt(2)
    v_perm_b32 v42, v28, v24, s6
    v_perm_b32 v46, v28, v24, s7
    v_perm_b32 v50, v29, v25, s6
    v_perm_b32 v54, v29, v25, s7
    v_perm_b32 v58, v30, v26, s6
    v_perm_b32 v62, v30, v26, s7
    v_perm_b32 v66, v31, v27, s6
    v_perm_b32 v70, v31, v27, s7
    s_waitcnt vmcnt(0)
    v_perm_b32 v43, v36, v32, s6
    v_perm_b32 v47, v36, v32, s7
    v_perm_b32 v51, v37, v33, s6
    v_perm_b32 v55, v37, v33, s7
    v_perm_b32 v59, v38, v34, s6
    v_perm_b32 v63, v38, v34, s7
    v_perm_b32 v67, v39, v35, s6
    v_perm_b32 v71, v39, v35, s7
    v_mfma_f32_16x16x32_bf16 v[88:91], v[40:43], v[72:75], 0
    v_mfma_f32_16x16x32_bf16 v[92:95], v[56:59], v[72:75], 0
    v_mfma_f32_16x16x32_bf16 v[88:91], v[44:47], v[76:79], v[88:91]
    v_mfma_f32_16x16x32_bf16 v[92:95], v[60:63], v[76:79], v[92:95]
    v_mfma_f32_16x16x32_bf16 v[88:91], v[48:51], v[80:83], v[88:91]
    v_mfma_f32_16x16x32_bf16 v[92:95], v[64:67], v[80:83], v[92:95]
    v_mfma_f32_16x16x32_bf16 v[88:91], v[52:55], v[84:87], v[88:91]
    v_mfma_f32_16x16x32_bf16 v[92:95], v[68:71], v[84:87], v[92:95]
    s_nop 6
    ds_write_b128 v118, v[88:91] offset:0
    ds_write_b128 v118, v[92:95] offset:1024
    s_lshl_b32 s15, s88, 2
    s_add_u32 s15, s15, 108928
    v_mov_b32 v5, s15
    ds_write_b32 v5, v124
    s_cmp_ge_u32 s88, 4
    s_cbranch_scc1 L_Fld
    v_bfe_u32 v4, v0, 1, 2
    v_lshlrev_b32 v4, 6, v4
    v_lshl_add_u32 v4, v2, 8, v4
    v_bfe_u32 v5, v0, 3, 1
    v_lshl_add_u32 v4, v5, 3, v4
    v_and_b32 v5, 1, v0
    v_lshl_add_u32 v4, v5, 2, v4
    s_lshl_b32 s15, s88, 4
    v_add_u32 v4, s15, v4
    s_lshr_b32 s91, s90, 3
    s_lshl_b32 s91, s91, 14
    s_and_b32 s13, s90, 1
    s_lshl_b32 s13, s13, 11
    s_add_u32 s91, s91, s13
    s_bfe_u32 s13, s90, 0x20001
    s_lshl_b32 s13, s13, 9
    s_add_u32 s91, s91, s13
    s_add_u32 s91, s91, 0x10000
    s_lshl_b32 s15, s88, 12
    s_add_u32 s91, s91, s15
    v_and_b32 v5, 7, v0
    v_lshlrev_b32 v5, 2, v5
    v_add_u32 v5, 108928, v5
    v_lshlrev_b32 v3, 3, v0
    s_mov_b32 s14, 0
L_G2s:
    ds_read_b32 v6, v5
    s_add_u32 s14, s14, 1
    s_cmp_gt_u32 s14, 4194304
    s_cbranch_scc1 L_end
    s_waitcnt lgkmcnt(0)
    v_cmp_eq_u32 vcc, 0, v6
    s_nop 0
    s_cmp_lg_u64 vcc, 0
    s_cbranch_scc0 L_G2s_ok
    s_sleep 1
    s_branch L_G2s
L_G2s_ok:
    ds_read2st64_b32 v[8:9], v4 offset0:0 offset1:4
    ds_read2st64_b32 v[10:11], v4 offset0:8 offset1:12
    ds_read2st64_b32 v[12:13], v4 offset0:16 offset1:20
    ds_read2st64_b32 v[14:15], v4 offset0:24 offset1:28
    ds_read2st64_b32 v[16:17], v4 offset0:32 offset1:36
    ds_read2st64_b32 v[18:19], v4 offset0:40 offset1:44
    ds_read2st64_b32 v[20:21], v4 offset0:48 offset1:52
    ds_read2st64_b32 v[22:23], v4 offset0:56 offset1:60
    s_waitcnt lgkmcnt(0)
    v_pk_add_f32 v[8:9], v[8:9], v[16:17]
    v_pk_add_f32 v[10:11], v[10:11], v[18:19]
    v_pk_add_f32 v[12:13], v[12:13], v[20:21]
    v_pk_add_f32 v[14:15], v[14:15], v[22:23]
    v_pk_add_f32 v[8:9], v[8:9], v[12:13]
    v_pk_add_f32 v[10:11], v[10:11], v[14:15]
    v_pk_add_f32 v[88:89], v[8:9], v[10:11]
    v_min_u32 v88, -2, v88
    v_min_u32 v89, -2, v89
    buffer_store_dwordx2 v[88:89], v3, s[48:51], s91 offen sc1
    s_branch L_Fld
L_G1b:
    v_and_b32 v112, 3, v0
    v_mul_u32_u24 v112, 1040, v112
    v_lshl_add_u32 v112, v2, 4, v112
    s_lshl_b32 s15, s3, 6
    s_add_u32 s15, s15, 32768
    v_add_u32 v112, s15, v112
    v_mov_b32 v72, 0
    v_mov_b32 v73, 0
    v_mov_b32 v74, 0
    v_mov_b32 v75, 0
    v_mov_b32 v76, 0
    v_mov_b32 v77, 0
    v_mov_b32 v78, 0
    v_mov_b32 v79, 0
    v_mov_b32 v80, 0
    v_mov_b32 v81, 0
    v_mov_b32 v82, 0
    v_mov_b32 v83, 0
    v_mov_b32 v84, 0
    v_mov_b32 v85, 0
    v_mov_b32 v86, 0
    v_mov_b32 v87, 0
    s_lshl_b32 s15, s3, 10
    v_add_u32 v118, s15, v7
    s_and_b32 s15, s3, 1
    s_lshl_b32 s15, s15, 6
    v_add_u32 v3, s15, v0
    v_lshlrev_b32 v116, 3, v3
    v_bfe_u32 v117, v3, 1, 2
    v_lshlrev_b32 v117, 11, v117
    v_lshrrev_b32 v3, 3, v3
    v_lshl_add_u32 v117, v3, 4, v117
    s_lshl_b32 s62, s4, 13
    s_lshl_b32 s15, s5, 8
    s_add_u32 s62, s62, s15
    s_add_u32 s62, s62, 0x1d0000
    s_mul_i32 s84, s4, 49152
    s_add_u32 s84, s84, 0xa0000
    s_add_u32 s85, s84, 8704
    s_add_u32 s86, s84, 17408
    s_add_u32 s87, s84, 26112
    s_add_u32 s88, s84, 34816
    v_mul_u32_u24 v114, 2176, v2
    s_lshl_b32 s15, s5, 8
    v_lshl_add_u32 v113, v1, 4, v114
    v_add_u32 v113, s15, v113
    s_lshr_b32 s15, s5, 1
    s_lshl_b32 s15, s15, 4
    v_add_u32 v114, s15, v114
    s_lshl_b32 s89, s5, 9
    s_add_u32 s89, s89, s84
    s_add_u32 s89, s89, 43520
    s_waitcnt lgkmcnt(0)
    s_mul_i32 s8, s46, 1664525
    s_add_u32 s8, s8, 1013904223
    s_mul_i32 s9, s47, 22695477
    s_add_u32 s9, s9, 1
    s_getreg_b32 s93, hwreg(HW_REG_XCC_ID, 0, 4)
    s_add_u32 s93, s93, s8
    v_mov_b32 v62, s93
    v_mov_b32 v63, s9
    s_cmp_lg_u32 s3, 0
    s_cbranch_scc1 L_G1c
    s_getreg_b32 s93, hwreg(HW_REG_XCC_ID, 0, 4)
    s_add_u32 s93, s93, s8
    s_lshl_b32 s81, s4, 5
    s_add_u32 s81, s81, s5
    s_lshl_b32 s81, s81, 8
    s_add_u32 s81, s81, 0x1e0000
    v_mov_b32 v56, s93
    v_mov_b32 v57, s9
    v_mov_b32 v58, 0
    s_mov_b64 exec, 1
    buffer_store_dwordx2 v[56:57], v58, s[48:51], s81 offen offset:8 sc1
    s_mov_b64 exec, -1
L_G1c:
    s_cmp_lg_u32 s3, 7
    s_cbranch_scc1 L_G1e
    v_lshlrev_b32 v64, 8, v0
    s_lshl_b32 s15, s4, 13
    s_add_u32 s15, s15, 0x1e0008
    s_mov_b32 s94, s93
    s_mov_b32 s95, s9
    s_mov_b32 s14, 0
    s_mov_b32 exec_lo, 0xfffff0ff
    s_mov_b32 exec_hi, 0x0
    s_waitcnt vmcnt(0)
L_G1x:
    s_sleep 8
    buffer_load_dwordx2 v[66:67], v64, s[48:51], s15 offen sc1
    s_add_u32 s14, s14, 1
    s_waitcnt vmcnt(0)
    v_cmp_ne_u64 vcc, s[94:95], v[66:67]
    s_nop 0
    s_mov_b32 s61, vcc_lo
    v_cmp_ne_u32 vcc, s9, v67
    s_cmp_lt_u32 s14, 4000
    s_cselect_b32 s13, vcc_lo, 0
    s_cmp_lg_u32 s13, 0
    s_cbranch_scc1 L_G1x
    s_mov_b64 exec, -1
    v_mov_b32 v59, s61
    ds_write_b32 v97, v59 offset:128
    v_mov_b32 v64, -1
    v_mov_b32 v65, -1
    v_mov_b32 v66, -1
    v_mov_b32 v67, -1
    v_lshlrev_b32 v57, 3, v0
    s_cmp_lg_u32 s61, 0
    s_cbranch_scc1 L_far_2
    buffer_store_dwordx4 v[64:67], v113, s[48:51], s84 offen
    buffer_store_dwordx4 v[64:67], v113, s[48:51], s85 offen
    buffer_store_dwordx4 v[64:67], v113, s[48:51], s86 offen
    buffer_store_dwordx4 v[64:67], v113, s[48:51], s87 offen
    buffer_store_dwordx4 v[64:67], v113, s[48:51], s88 offen
    buffer_store_dwordx2 v[64:65], v57, s[48:51], s89 offen
    s_branch L_st_3
L_far_2:
    buffer_store_dwordx4 v[64:67], v113, s[48:51], s84 offen sc1
    buffer_store_dwordx4 v[64:67], v113, s[48:51], s85 offen sc1
    buffer_store_dwordx4 v[64:67], v113, s[48:51], s86 offen sc1
    buffer_store_dwordx4 v[64:67], v113, s[48:51], s87 offen sc1
    buffer_store_dwordx4 v[64:67], v113, s[48:51], s88 offen sc1
    buffer_store_dwordx2 v[64:65], v57, s[48:51], s89 offen sc1
L_st_3:
    s_waitcnt vmcnt(0)
L_G1e:
    s_cmp_lt_u32 s3, 8
    s_cbranch_scc1 L_G1d
    s_sub_u32 s15, s3, 8
    s_lshl_b32 s80, s15, 10
    s_add_u32 s80, s80, 0x1c0000
    v_mul_u32_u24 v6, 1040, v2
    v_lshl_add_u32 v6, v1, 3, v6
    s_lshl_b32 s15, s15, 7
    s_add_u32 s15, s15, 32768
    v_add_u32 v6, s15, v6
    s_waitcnt vmcnt(0)
    v_perm_b32 v24, v10, v8, s6
    v_perm_b32 v28, v10, v8, s7
    v_perm_b32 v32, v11, v9, s6
    v_perm_b32 v36, v11, v9, s7
    v_perm_b32 v25, v14, v12, s6
    v_perm_b32 v29, v14, v12, s7
    v_perm_b32 v33, v15, v13, s6
    v_perm_b32 v37, v15, v13, s7
    v_perm_b32 v26, v18, v16, s6
    v_perm_b32 v30, v18, v16, s7
    v_perm_b32 v34, v19, v17, s6
    v_perm_b32 v38, v19, v17, s7
    v_perm_b32 v27, v22, v20, s6
    v_perm_b32 v31, v22, v20, s7
    v_perm_b32 v35, v23, v21, s6
    v_perm_b32 v39, v23, v21, s7
    s_mov_b32 s14, 0
    s_mov_b64 s[64:65], -1
L_poll_4:
    s_mov_b64 exec, s[64:65]
    buffer_load_dwordx4 v[56:59], v7, s[48:51], s80 offen sc1
    s_add_u32 s14, s14, 1
    s_cmp_gt_u32 s14, 1048576
    s_cbranch_scc1 L_end
    s_waitcnt vmcnt(0)
    v_cmp_ne_u64 s[64:65], s[8:9], v[58:59]
    s_nop 0
    s_cmp_lg_u64 s[64:65], 0
    s_cbranch_scc1 L_poll_4
    s_mov_b64 exec, -1
    ds_write_b64 v6, v[56:57]
    s_branch L_G1f
L_G1d:
    s_waitcnt vmcnt(0)
    s_sub_u32 s14, s3, 0
    s_cmp_ge_u32 s14, 7
    s_cbranch_scc1 L_G1h
    v_mov_b32 v64, -1
    v_mov_b32 v65, -1
    v_mov_b32 v66, -1
    v_mov_b32 v67, -1
    s_lshl_b32 s15, s4, 3
    s_add_u32 s15, s15, s5
    s_mul_i32 s15, s15, 7
    s_add_u32 s15, s15, s14
    s_lshl_b32 s15, s15, 10
    s_add_u32 s15, s15, 0x30000
    buffer_store_dwordx4 v[64:67], v7, s[48:51], s15 offen sc1
L_G1h:
    v_perm_b32 v24, v10, v8, s6
    v_perm_b32 v28, v10, v8, s7
    v_perm_b32 v32, v11, v9, s6
    v_perm_b32 v36, v11, v9, s7
    v_perm_b32 v25, v14, v12, s6
    v_perm_b32 v29, v14, v12, s7
    v_perm_b32 v33, v15, v13, s6
    v_perm_b32 v37, v15, v13, s7
    v_perm_b32 v26, v18, v16, s6
    v_perm_b32 v30, v18, v16, s7
    v_perm_b32 v34, v19, v17, s6
    v_perm_b32 v38, v19, v17, s7
    v_perm_b32 v27, v22, v20, s6
    v_perm_b32 v31, v22, v20, s7
    v_perm_b32 v35, v23, v21, s6
    v_perm_b32 v39, v23, v21, s7
L_G1f:
    s_waitcnt lgkmcnt(0)
    s_barrier
    s_mov_b32 exec_lo, 0xf000f
    s_mov_b32 exec_hi, 0xf000f
    ds_read_b128 v[72:75], v112
    s_mov_b64 exec, -1
    ds_read_b32 v59, v97 offset:128
    s_waitcnt lgkmcnt(1)
    v_mfma_f32_16x16x32_bf16 v[104:107], v[24:27], v[72:75], 0
    v_mov_b32_dpp v76, v72 row_ror:4 row_mask:0xf bank_mask:0x2
    v_mov_b32_dpp v77, v73 row_ror:4 row_mask:0xf bank_mask:0x2
    v_mov_b32_dpp v78, v74 row_ror:4 row_mask:0xf bank_mask:0x2
    v_mov_b32_dpp v79, v75 row_ror:4 row_mask:0xf bank_mask:0x2
    s_nop 1
    v_mfma_f32_16x16x32_bf16 v[104:107], v[28:31], v[76:79], v[104:107]
    v_mov_b32_dpp v80, v72 row_ror:8 row_mask:0xf bank_mask:0x4
    v_mov_b32_dpp v81, v73 row_ror:8 row_mask:0xf bank_mask:0x4
    v_mov_b32_dpp v82, v74 row_ror:8 row_mask:0xf bank_mask:0x4
    v_mov_b32_dpp v83, v75 row_ror:8 row_mask:0xf bank_mask:0x4
    s_nop 1
    v_mfma_f32_16x16x32_bf16 v[104:107], v[32:35], v[80:83], v[104:107]
    v_mov_b32_dpp v84, v72 row_ror:12 row_mask:0xf bank_mask:0x8
    v_mov_b32_dpp v85, v73 row_ror:12 row_mask:0xf bank_mask:0x8
    v_mov_b32_dpp v86, v74 row_ror:12 row_mask:0xf bank_mask:0x8
    v_mov_b32_dpp v87, v75 row_ror:12 row_mask:0xf bank_mask:0x8
    s_nop 1
    v_mfma_f32_16x16x32_bf16 v[104:107], v[36:39], v[84:87], v[104:107]
    s_nop 7
    ds_write_b128 v118, v[104:107] offset:0
    s_waitcnt lgkmcnt(0)
    v_readfirstlane_b32 s61, v59
    s_barrier
    s_cmp_ge_u32 s3, 2
    s_cbranch_scc1 L_G1O
    ds_read_b64 v[72:73], v116 offset:0
    ds_read_b64 v[74:75], v116 offset:1024
    ds_read_b64 v[76:77], v116 offset:2048
    ds_read_b64 v[78:79], v116 offset:3072
    ds_read_b64 v[80:81], v116 offset:4096
    ds_read_b64 v[82:83], v116 offset:5120
    ds_read_b64 v[84:85], v116 offset:6144
    ds_read_b64 v[86:87], v116 offset:7168
    ds_read_b64 v[88:89], v116 offset:8192
    ds_read_b64 v[90:91], v116 offset:9216
    ds_read_b64 v[92:93], v116 offset:10240
    ds_read_b64 v[94:95], v116 offset:11264
    ds_read_b64 v[96:97], v116 offset:12288
    ds_read_b64 v[98:99], v116 offset:13312
    ds_read_b64 v[100:101], v116 offset:14336
    ds_read_b64 v[102:103], v116 offset:15360
    s_waitcnt lgkmcnt(8)
    v_pk_add_f32 v[72:73], v[72:73], v[80:81]
    v_pk_add_f32 v[74:75], v[74:75], v[82:83]
    v_pk_add_f32 v[76:77], v[76:77], v[84:85]
    v_pk_add_f32 v[78:79], v[78:79], v[86:87]
    v_pk_add_f32 v[72:73], v[72:73], v[76:77]
    v_pk_add_f32 v[74:75], v[74:75], v[78:79]
    s_waitcnt lgkmcnt(0)
    v_pk_add_f32 v[88:89], v[88:89], v[96:97]
    v_pk_add_f32 v[90:91], v[90:91], v[98:99]
    v_pk_add_f32 v[92:93], v[92:93], v[100:101]
    v_pk_add_f32 v[94:95], v[94:95], v[102:103]
    v_pk_add_f32 v[88:89], v[88:89], v[92:93]
    v_pk_add_f32 v[90:91], v[90:91], v[94:95]
    v_pk_add_f32 v[72:73], v[72:73], v[88:89]
    v_pk_add_f32 v[74:75], v[74:75], v[90:91]
    v_pk_add_f32 v[60:61], v[72:73], v[74:75]
    v_cvt_pk_bf16_f32 v60, v60, v61
    s_nop 1
    v_mov_b32_dpp v61, v60 quad_perm:[1,0,3,2] row_mask:0xf bank_mask:0xf
    s_mov_b32 exec_lo, 0x55555555
    s_mov_b32 exec_hi, 0x55555555
    s_cmp_lg_u32 s61, 0
    s_cbranch_scc1 L_far_5
    buffer_store_dwordx4 v[60:63], v117, s[48:51], s62 offen
    s_branch L_st_6
L_far_5:
    buffer_store_dwordx4 v[60:63], v117, s[48:51], s62 offen sc1
L_st_6:
    s_mov_b64 exec, -1
L_G1O:
    s_mov_b32 s52, s24
    s_mov_b32 s53, s25
    s_mov_b32 s54, 0x400000
    s_mov_b32 s55, 0x20000
    v_lshlrev_b32 v5, 11, v2
    v_lshl_add_u32 v5, v1, 3, v5
    s_lshl_b32 s64, s4, 19
    s_lshl_b32 s15, s3, 15
    s_add_u32 s64, s64, s15
    s_lshl_b32 s15, s5, 7
    s_add_u32 s64, s64, s15
    s_add_u32 s65, s64, 8192
    s_add_u32 s66, s64, 16384
    s_add_u32 s67, s64, 24576
    s_barrier
    buffer_load_dwordx2 v[40:41], v5, s[52:55], s64 offen nt
    buffer_load_dwordx2 v[42:43], v5, s[52:55], s65 offen nt
    buffer_load_dwordx2 v[44:45], v5, s[52:55], s66 offen nt
    buffer_load_dwordx2 v[46:47], v5, s[52:55], s67 offen nt
    buffer_load_dwordx2 v[48:49], v5, s[52:55], s64 offen offset:1024 nt
    buffer_load_dwordx2 v[50:51], v5, s[52:55], s65 offen offset:1024 nt
    buffer_load_dwordx2 v[52:53], v5, s[52:55], s66 offen offset:1024 nt
    buffer_load_dwordx2 v[54:55], v5, s[52:55], s67 offen offset:1024 nt
    s_cmp_lg_u32 s3, 15
    s_cbranch_scc1 L_G1p
    v_lshlrev_b32 v57, 3, v0
    buffer_load_dwordx4 v[60:63], v113, s[48:51], s84 offen sc1
    buffer_load_dwordx4 v[60:63], v113, s[48:51], s85 offen sc1
    buffer_load_dwordx4 v[60:63], v113, s[48:51], s86 offen sc1
    buffer_load_dwordx4 v[60:63], v113, s[48:51], s87 offen sc1
    buffer_load_dwordx4 v[60:63], v113, s[48:51], s88 offen sc1
    buffer_load_dwordx2 v[60:61], v57, s[48:51], s89 offen sc1
L_G1p:
    v_lshrrev_b32 v3, 3, v116
    v_bfe_u32 v117, v3, 1, 2
    v_lshlrev_b32 v117, 14, v117
    v_lshrrev_b32 v6, 3, v3
    v_lshl_add_u32 v117, v6, 4, v117
    v_and_b32 v6, 1, v3
    v_lshl_add_u32 v117, v6, 3, v117
    v_and_b32 v119, 3, v0
    v_lshlrev_b32 v119, 4, v119
    v_lshl_add_u32 v119, v2, 6, v119
    v_mov_b32 v72, 0
    v_mov_b32 v73, 0
    v_mov_b32 v74, 0
    v_mov_b32 v75, 0
    v_mov_b32 v76, 0
    v_mov_b32 v77, 0
    v_mov_b32 v78, 0
    v_mov_b32 v79, 0
    v_mov_b32 v80, 0
    v_mov_b32 v81, 0
    v_mov_b32 v82, 0
    v_mov_b32 v83, 0
    v_mov_b32 v84, 0
    v_mov_b32 v85, 0
    v_mov_b32 v86, 0
    v_mov_b32 v87, 0
    s_lshl_b32 s63, s3, 8
    s_add_u32 s63, s63, s84
    s_add_u32 s63, s63, 43520
    s_lshl_b32 s62, s4, 11
    s_lshl_b32 s13, s5, 8
    s_add_u32 s62, s62, s13
    s_add_u32 s62, s62, 0x20000
    s_waitcnt vmcnt(0)
    v_perm_b32 v24, v42, v40, s6
    v_perm_b32 v28, v42, v40, s7
    v_perm_b32 v32, v43, v41, s6
    v_perm_b32 v36, v43, v41, s7
    v_perm_b32 v25, v46, v44, s6
    v_perm_b32 v29, v46, v44, s7
    v_perm_b32 v33, v47, v45, s6
    v_perm_b32 v37, v47, v45, s7
    v_perm_b32 v26, v50, v48, s6
    v_perm_b32 v30, v50, v48, s7
    v_perm_b32 v34, v51, v49, s6
    v_perm_b32 v38, v51, v49, s7
    v_perm_b32 v27, v54, v52, s6
    v_perm_b32 v31, v54, v52, s7
    v_perm_b32 v35, v55, v53, s6
    v_perm_b32 v39, v55, v53, s7
    s_cmp_eq_u32 s3, 4
    s_cbranch_scc1 L_G1C
    s_cmp_lg_u32 s3, 5
    s_cbranch_scc1 L_G1O2
    s_cmp_lg_u32 s5, 7
    s_cbranch_scc1 L_G1O2
    v_subrev_u32 v113, 1024, v113
    v_subrev_u32 v114, 32, v114
    s_sub_u32 s89, s89, 2048
L_G1C:
    v_lshrrev_b32 v6, 1, v1
    v_lshlrev_b32 v6, 6, v6
    v_lshl_add_u32 v6, v2, 4, v6
    v_and_b32 v9, 1, v0
    v_lshl_add_u32 v6, v9, 3, v6
    s_mov_b32 s14, 0
    s_mov_b64 s[64:65], -1
    s_mov_b64 s[66:67], -1
    s_mov_b64 s[68:69], -1
    s_mov_b64 s[70:71], -1
    s_mov_b64 s[72:73], -1
L_poll_7:
    s_sleep 3
    s_mov_b64 exec, s[64:65]
    buffer_load_dwordx4 v[88:91], v114, s[48:51], s84 offen offset:2048 sc1
    s_mov_b64 exec, s[66:67]
    buffer_load_dwordx4 v[92:95], v114, s[48:51], s85 offen offset:2048 sc1
    s_mov_b64 exec, s[68:69]
    buffer_load_dwordx4 v[96:99], v114, s[48:51], s86 offen offset:2048 sc1
    s_mov_b64 exec, s[70:71]
    buffer_load_dwordx4 v[100:103], v114, s[48:51], s87 offen offset:2048 sc1
    s_mov_b64 exec, s[72:73]
    buffer_load_dwordx4 v[104:107], v114, s[48:51], s88 offen offset:2048 sc1
    s_add_u32 s14, s14, 1
    s_cmp_gt_u32 s14, 1048576
    s_cbranch_scc1 L_end
    s_waitcnt vmcnt(4)
    s_mov_b64 exec, s[64:65]
    v_cmp_ne_u64 s[64:65], s[8:9], v[90:91]
    s_waitcnt vmcnt(3)
    s_mov_b64 exec, s[66:67]
    v_cmp_ne_u64 s[66:67], s[8:9], v[94:95]
    s_waitcnt vmcnt(2)
    s_mov_b64 exec, s[68:69]
    v_cmp_ne_u64 s[68:69], s[8:9], v[98:99]
    s_waitcnt vmcnt(1)
    s_mov_b64 exec, s[70:71]
    v_cmp_ne_u64 s[70:71], s[8:9], v[102:103]
    s_waitcnt vmcnt(0)
    s_mov_b64 exec, s[72:73]
    v_cmp_ne_u64 s[72:73], s[8:9], v[106:107]
    s_or_b64 s[46:47], s[64:65], s[66:67]
    s_or_b64 s[46:47], s[46:47], s[68:69]
    s_or_b64 s[46:47], s[46:47], s[70:71]
    s_or_b64 s[46:47], s[46:47], s[72:73]
    s_cbranch_scc1 L_poll_7
    s_mov_b64 exec, -1
    s_cmp_eq_u32 s5, 3
    s_cbranch_scc1 L_G1O2
    buffer_load_dwordx4 v[40:43], v113, s[48:51], s84 offen sc1
    buffer_load_dwordx4 v[44:47], v113, s[48:51], s85 offen sc1
    buffer_load_dwordx4 v[48:51], v113, s[48:51], s86 offen sc1
    buffer_load_dwordx4 v[52:55], v113, s[48:51], s87 offen sc1
    buffer_load_dwordx4 v[56:59], v113, s[48:51], s88 offen sc1
    v_max3_f32 v8, v88, v92, v96
    v_max3_f32 v8, v8, v100, v104
    v_sub_f32 v88, v88, v8
    v_sub_f32 v92, v92, v8
    v_sub_f32 v96, v96, v8
    v_sub_f32 v100, v100, v8
    v_sub_f32 v104, v104, v8
    v_exp_f32 v88, v88
    v_exp_f32 v92, v92
    v_exp_f32 v96, v96
    v_exp_f32 v100, v100
    v_exp_f32 v104, v104
    v_add_f32 v8, v88, v92
    v_add_f32 v9, v96, v100
    v_add_f32 v8, v8, v104
    v_add_f32 v8, v8, v9
    v_rcp_f32 v8, v8
    s_nop 0
    v_mul_f32 v88, v88, v8
    v_mul_f32 v92, v92, v8
    v_mul_f32 v96, v96, v8
    v_mul_f32 v100, v100, v8
    v_mul_f32 v104, v104, v8
    s_mov_b32 s14, 0
    s_waitcnt vmcnt(4)
    v_max3_u32 v8, v40, v41, v42
    v_max_u32 v8, v8, v43
    v_cmp_eq_u32 s[64:65], -1, v8
    s_waitcnt vmcnt(3)
    v_max3_u32 v8, v44, v45, v46
    v_max_u32 v8, v8, v47
    v_cmp_eq_u32 s[66:67], -1, v8
    s_waitcnt vmcnt(2)
    v_max3_u32 v8, v48, v49, v50
    v_max_u32 v8, v8, v51
    v_cmp_eq_u32 s[68:69], -1, v8
    s_waitcnt vmcnt(1)
    v_max3_u32 v8, v52, v53, v54
    v_max_u32 v8, v8, v55
    v_cmp_eq_u32 s[70:71], -1, v8
    s_waitcnt vmcnt(0)
    v_max3_u32 v8, v56, v57, v58
    v_max_u32 v8, v8, v59
    v_cmp_eq_u32 s[72:73], -1, v8
    s_or_b64 s[46:47], s[64:65], s[66:67]
    s_or_b64 s[46:47], s[46:47], s[68:69]
    s_or_b64 s[46:47], s[46:47], s[70:71]
    s_or_b64 s[46:47], s[46:47], s[72:73]
    s_cbranch_scc0 L_poll_8_d
L_poll_8:
    s_mov_b64 exec, s[64:65]
    buffer_load_dwordx4 v[40:43], v113, s[48:51], s84 offen sc1
    s_mov_b64 exec, s[66:67]
    buffer_load_dwordx4 v[44:47], v113, s[48:51], s85 offen sc1
    s_mov_b64 exec, s[68:69]
    buffer_load_dwordx4 v[48:51], v113, s[48:51], s86 offen sc1
    s_mov_b64 exec, s[70:71]
    buffer_load_dwordx4 v[52:55], v113, s[48:51], s87 offen sc1
    s_mov_b64 exec, s[72:73]
    buffer_load_dwordx4 v[56:59], v113, s[48:51], s88 offen sc1
    s_add_u32 s14, s14, 1
    s_cmp_gt_u32 s14, 1048576
    s_cbranch_scc1 L_end
    s_waitcnt vmcnt(4)
    s_mov_b64 exec, s[64:65]
    v_max3_u32 v8, v40, v41, v42
    v_max_u32 v8, v8, v43
    v_cmp_eq_u32 s[64:65], -1, v8
    s_waitcnt vmcnt(3)
    s_mov_b64 exec, s[66:67]
    v_max3_u32 v8, v44, v45, v46
    v_max_u32 v8, v8, v47
    v_cmp_eq_u32 s[66:67], -1, v8
    s_waitcnt vmcnt(2)
    s_mov_b64 exec, s[68:69]
    v_max3_u32 v8, v48, v49, v50
    v_max_u32 v8, v8, v51
    v_cmp_eq_u32 s[68:69], -1, v8
    s_waitcnt vmcnt(1)
    s_mov_b64 exec, s[70:71]
    v_max3_u32 v8, v52, v53, v54
    v_max_u32 v8, v8, v55
    v_cmp_eq_u32 s[70:71], -1, v8
    s_waitcnt vmcnt(0)
    s_mov_b64 exec, s[72:73]
    v_max3_u32 v8, v56, v57, v58
    v_max_u32 v8, v8, v59
    v_cmp_eq_u32 s[72:73], -1, v8
    s_or_b64 s[46:47], s[64:65], s[66:67]
    s_or_b64 s[46:47], s[46:47], s[68:69]
    s_or_b64 s[46:47], s[46:47], s[70:71]
    s_or_b64 s[46:47], s[46:47], s[72:73]
    s_cbranch_scc1 L_poll_8
    s_mov_b64 exec, -1
L_poll_8_d:
    v_pk_mul_f32 v[12:13], v[40:41], v[88:89] op_sel_hi:[1,0]
    v_pk_mul_f32 v[14:15], v[42:43], v[88:89] op_sel_hi:[1,0]
    v_pk_fma_f32 v[12:13], v[44:45], v[92:93], v[12:13] op_sel_hi:[1,0,1]
    v_pk_fma_f32 v[14:15], v[46:47], v[92:93], v[14:15] op_sel_hi:[1,0,1]
    v_pk_fma_f32 v[12:13], v[48:49], v[96:97], v[12:13] op_sel_hi:[1,0,1]
    v_pk_fma_f32 v[14:15], v[50:51], v[96:97], v[14:15] op_sel_hi:[1,0,1]
    v_pk_fma_f32 v[12:13], v[52:53], v[100:101], v[12:13] op_sel_hi:[1,0,1]
    v_pk_fma_f32 v[14:15], v[54:55], v[100:101], v[14:15] op_sel_hi:[1,0,1]
    v_pk_fma_f32 v[12:13], v[56:57], v[104:105], v[12:13] op_sel_hi:[1,0,1]
    v_pk_fma_f32 v[14:15], v[58:59], v[104:105], v[14:15] op_sel_hi:[1,0,1]
    v_cvt_pk_bf16_f32 v10, v12, v13
    v_cvt_pk_bf16_f32 v11, v14, v15
    v_min_u32 v10, -2, v10
    v_min_u32 v11, -2, v11
    s_cmp_lg_u32 s61, 0
    s_cbranch_scc1 L_far_9
    buffer_store_dwordx2 v[10:11], v6, s[48:51], s89 offen
    s_branch L_st_10
L_far_9:
    buffer_store_dwordx2 v[10:11], v6, s[48:51], s89 offen sc1
L_st_10:
L_G1O2:
    s_barrier
    s_mov_b32 s14, 0
    s_mov_b32 s64, 0xf000f
    s_mov_b32 s65, 0xf000f
L_poll_11:
    s_mov_b64 exec, s[64:65]
    buffer_load_dwordx4 v[72:75], v119, s[48:51], s63 offen sc1
    s_add_u32 s14, s14, 1
    s_cmp_gt_u32 s14, 1048576
    s_cbranch_scc1 L_end
    s_waitcnt vmcnt(0)
    v_max3_u32 v8, v72, v73, v74
    v_max_u32 v8, v8, v75
    v_cmp_eq_u32 s[64:65], -1, v8
    s_nop 0
    s_cmp_lg_u64 s[64:65], 0
    s_cbranch_scc1 L_poll_11
    s_mov_b64 exec, -1
    v_mfma_f32_16x16x32_bf16 v[104:107], v[24:27], v[72:75], 0
    v_mov_b32_dpp v76, v72 row_ror:4 row_mask:0xf bank_mask:0x2
    v_mov_b32_dpp v77, v73 row_ror:4 row_mask:0xf bank_mask:0x2
    v_mov_b32_dpp v78, v74 row_ror:4 row_mask:0xf bank_mask:0x2
    v_mov_b32_dpp v79, v75 row_ror:4 row_mask:0xf bank_mask:0x2
    s_nop 1
    v_mfma_f32_16x16x32_bf16 v[104:107], v[28:31], v[76:79], v[104:107]
    v_mov_b32_dpp v80, v72 row_ror:8 row_mask:0xf bank_mask:0x4
    v_mov_b32_dpp v81, v73 row_ror:8 row_mask:0xf bank_mask:0x4
    v_mov_b32_dpp v82, v74 row_ror:8 row_mask:0xf bank_mask:0x4
    v_mov_b32_dpp v83, v75 row_ror:8 row_mask:0xf bank_mask:0x4
    s_nop 1
    v_mfma_f32_16x16x32_bf16 v[104:107], v[32:35], v[80:83], v[104:107]
    v_mov_b32_dpp v84, v72 row_ror:12 row_mask:0xf bank_mask:0x8
    v_mov_b32_dpp v85, v73 row_ror:12 row_mask:0xf bank_mask:0x8
    v_mov_b32_dpp v86, v74 row_ror:12 row_mask:0xf bank_mask:0x8
    v_mov_b32_dpp v87, v75 row_ror:12 row_mask:0xf bank_mask:0x8
    s_nop 1
    v_mfma_f32_16x16x32_bf16 v[104:107], v[36:39], v[84:87], v[104:107]
    s_nop 7
    ds_write_b128 v118, v[104:107] offset:0
    s_waitcnt lgkmcnt(0)
    s_barrier
    s_cmp_ge_u32 s3, 2
    s_cbranch_scc1 L_fin
    ds_read_b64 v[8:9], v116 offset:0
    ds_read_b64 v[10:11], v116 offset:1024
    ds_read_b64 v[12:13], v116 offset:2048
    ds_read_b64 v[14:15], v116 offset:3072
    ds_read_b64 v[16:17], v116 offset:4096
    ds_read_b64 v[18:19], v116 offset:5120
    ds_read_b64 v[20:21], v116 offset:6144
    ds_read_b64 v[22:23], v116 offset:7168
    ds_read_b64 v[24:25], v116 offset:8192
    ds_read_b64 v[26:27], v116 offset:9216
    ds_read_b64 v[28:29], v116 offset:10240
    ds_read_b64 v[30:31], v116 offset:11264
    ds_read_b64 v[32:33], v116 offset:12288
    ds_read_b64 v[34:35], v116 offset:13312
    ds_read_b64 v[36:37], v116 offset:14336
    ds_read_b64 v[38:39], v116 offset:15360
    s_waitcnt lgkmcnt(8)
    v_pk_add_f32 v[8:9], v[8:9], v[16:17]
    v_pk_add_f32 v[10:11], v[10:11], v[18:19]
    v_pk_add_f32 v[12:13], v[12:13], v[20:21]
    v_pk_add_f32 v[14:15], v[14:15], v[22:23]
    v_pk_add_f32 v[8:9], v[8:9], v[12:13]
    v_pk_add_f32 v[10:11], v[10:11], v[14:15]
    s_waitcnt lgkmcnt(0)
    v_pk_add_f32 v[24:25], v[24:25], v[32:33]
    v_pk_add_f32 v[26:27], v[26:27], v[34:35]
    v_pk_add_f32 v[28:29], v[28:29], v[36:37]
    v_pk_add_f32 v[30:31], v[30:31], v[38:39]
    v_pk_add_f32 v[24:25], v[24:25], v[28:29]
    v_pk_add_f32 v[26:27], v[26:27], v[30:31]
    v_pk_add_f32 v[8:9], v[8:9], v[24:25]
    v_pk_add_f32 v[10:11], v[10:11], v[26:27]
    v_pk_add_f32 v[60:61], v[8:9], v[10:11]
    v_min_u32 v60, -2, v60
    v_min_u32 v61, -2, v61
    buffer_store_dwordx2 v[60:61], v117, s[48:51], s62 offen sc1
    s_branch L_fin
L_Ahelp:
    s_cmp_ge_u32 s3, 13
    s_cbranch_scc1 L_Ah1
    v_mov_b32 v12, 0
    v_mov_b32 v13, 0
    v_mov_b32 v14, 0
    v_mov_b32 v15, 0
    s_lshl_b32 s15, s3, 13
    v_add_u32 v3, s15, v7
    ds_write_b128 v3, v[12:15] offset:0
    ds_write_b128 v3, v[12:15] offset:1024
    ds_write_b128 v3, v[12:15] offset:2048
    ds_write_b32 v97, v124 offset:432
    ds_write_b32 v97, v124 offset:720
    s_waitcnt lgkmcnt(0)
    s_branch L_fin
L_Ah1:
    s_waitcnt lgkmcnt(0)
    s_mul_i32 s8, s46, 1664525
    s_add_u32 s8, s8, 1013904223
    s_mul_i32 s9, s47, 22695477
    s_add_u32 s9, s9, 1
    s_cmp_eq_u32 s3, 13
    s_cbranch_scc1 L_Ah13
    s_getreg_b32 s93, hwreg(HW_REG_XCC_ID, 0, 4)
    s_add_u32 s93, s93, s8
    s_lshl_b32 s81, s4, 5
    s_add_u32 s81, s81, s5
    s_lshl_b32 s81, s81, 8
    s_add_u32 s81, s81, 0x1e0000
    v_mov_b32 v20, s93
    v_mov_b32 v21, s9
    v_mov_b32 v22, 0
    s_mov_b64 exec, 1
    buffer_store_dwordx2 v[20:21], v22, s[48:51], s81 offen offset:8 sc1
    s_mov_b64 exec, -1
    v_lshlrev_b32 v5, 2, v0
    v_add_u32 v5, 107776, v5
    s_mul_i32 s60, s4, 49152
    s_lshl2_add_u32 s15, s11, s10
    s_mul_i32 s15, s15, 2176
    s_add_u32 s60, s60, s15
    s_add_u32 s60, s60, 0xa0000
    v_lshlrev_b32 v26, 2, v1
    v_add_u32 v26, 108928, v26
    v_cmp_gt_u32 s[82:83], s62, v1
    v_lshlrev_b32 v3, 4, v2
    v_add_u32 v3, 2048, v3
    v_mov_b32 v33, 0
    v_mov_b32 v34, s8
    v_mov_b32 v35, s9
    v_mov_b32 v30, 0x3fb8aa3b
    s_mov_b32 s14, 0
L_Ahw:
    ds_read_b32 v27, v26
    ds_read_b32 v17, v5 offset:256
    ds_read_b32 v16, v5
    ds_read_b32 v28, v97 offset:4
    s_add_u32 s14, s14, 1
    s_cmp_gt_u32 s14, 4194304
    s_cbranch_scc1 L_end
    s_waitcnt lgkmcnt(0)
    v_cmp_eq_u32 vcc, 0, v27
    s_nop 0
    s_and_b64 vcc, vcc, s[82:83]
    s_cbranch_scc0 L_Ahw_ok
    s_sleep 1
    s_branch L_Ahw
L_Ahw_ok:
    v_mov_b32 v18, 0xff800000
    v_readfirstlane_b32 s61, v28
    v_cndmask_b32 v16, v18, v16, s[82:83]
    v_cndmask_b32 v17, 0, v17, s[82:83]
    v_mov_b32 v18, v16
    s_nop 1
    v_max_f32_dpp v18, v18, v18 quad_perm:[1,0,3,2] row_mask:0xf bank_mask:0xf
    s_nop 1
    v_max_f32_dpp v18, v18, v18 quad_perm:[2,3,0,1] row_mask:0xf bank_mask:0xf
    s_nop 1
    v_max_f32_dpp v18, v18, v18 row_half_mirror row_mask:0xf bank_mask:0xf
    s_nop 1
    v_max_f32_dpp v18, v18, v18 row_mirror row_mask:0xf bank_mask:0xf
    v_sub_f32 v16, v16, v18
    v_mul_f32 v16, v30, v16
    v_exp_f32 v16, v16
    s_nop 0
    v_mul_f32 v17, v16, v17
    s_nop 1
    v_add_f32_dpp v17, v17, v17 quad_perm:[1,0,3,2] row_mask:0xf bank_mask:0xf
    s_nop 1
    v_add_f32_dpp v17, v17, v17 quad_perm:[2,3,0,1] row_mask:0xf bank_mask:0xf
    s_nop 1
    v_add_f32_dpp v17, v17, v17 row_half_mirror row_mask:0xf bank_mask:0xf
    s_nop 1
    v_add_f32_dpp v17, v17, v17 row_mirror row_mask:0xf bank_mask:0xf
    v_rcp_f32 v19, v17
    v_log_f32 v17, v17
    v_mul_f32 v16, v16, v19
    ds_write_b32 v5, v16 offset:768
    v_fma_f32 v32, v18, v30, v17
    s_mov_b32 exec_lo, 0x10001
    s_mov_b32 exec_hi, 0x10001
    s_cmp_lg_u32 s61, 0
    s_cbranch_scc1 L_far_12
    buffer_store_dwordx4 v[32:35], v3, s[48:51], s60 offen
    s_branch L_st_13
L_far_12:
    buffer_store_dwordx4 v[32:35], v3, s[48:51], s60 offen sc1
L_st_13:
    s_mov_b64 exec, -1
    s_waitcnt lgkmcnt(0)
    s_barrier
    s_branch L_fin
L_Ah13:
    s_lshl2_add_u32 s80, s4, s10
    s_lshl_b32 s80, s80, 11
    s_add_u32 s80, s80, 0x1d0000
    buffer_load_dwordx4 v[32:35], v7, s[48:51], s80 offen sc1
    buffer_load_dwordx4 v[36:39], v7, s[48:51], s80 offen offset:1024 sc1
    v_and_b32 v4, 3, v0
    v_lshlrev_b32 v4, 1, v4
    v_bfe_u32 v3, v0, 2, 3
    v_lshl_add_u32 v4, v3, 5, v4
    v_lshrrev_b32 v3, 5, v0
    v_mul_u32_u24 v3, 288, v3
    v_add_u32 v4, v4, v3
    v_add_u32 v4, 106496, v4
    v_mov_b32 v16, 1
    s_getreg_b32 s93, hwreg(HW_REG_XCC_ID, 0, 4)
    s_add_u32 s93, s93, s8
    s_mov_b32 s14, 0
L_Aqs:
    ds_read_b32 v100, v97 offset:416
    s_add_u32 s14, s14, 1
    s_cmp_gt_u32 s14, 4194304
    s_cbranch_scc1 L_end
    s_waitcnt lgkmcnt(0)
    v_readfirstlane_b32 s15, v100
    s_nop 0
    s_cmp_eq_u32 s15, 0
    s_cbranch_scc0 L_Aqs_ok
    s_sleep 1
    s_branch L_Aqs
L_Aqs_ok:
    buffer_load_dwordx4 v[32:35], v7, s[48:51], s80 offen sc1
    buffer_load_dwordx4 v[36:39], v7, s[48:51], s80 offen offset:1024 sc1
    s_sleep 10
    buffer_load_dwordx4 v[40:43], v7, s[48:51], s80 offen sc1
    buffer_load_dwordx4 v[44:47], v7, s[48:51], s80 offen offset:1024 sc1
    s_sleep 10
    buffer_load_dwordx4 v[48:51], v7, s[48:51], s80 offen sc1
    buffer_load_dwordx4 v[52:55], v7, s[48:51], s80 offen offset:1024 sc1
    s_sleep 10
    buffer_load_dwordx4 v[56:59], v7, s[48:51], s80 offen sc1
    buffer_load_dwordx4 v[60:63], v7, s[48:51], s80 offen offset:1024 sc1
    s_mov_b32 s14, 0
L_Aring:
    s_add_u32 s14, s14, 1
    s_cmp_gt_u32 s14, 1048576
    s_cbranch_scc1 L_end
    s_waitcnt vmcnt(6)
    v_subrev_u32 v24, s8, v34
    v_subrev_u32 v25, s8, v38
    v_or_b32 v24, v24, v25
    v_lshrrev_b32 v24, 4, v24
    v_xor_b32 v25, s9, v35
    v_xor_b32 v26, s9, v39
    v_or3_b32 v24, v24, v25, v26
    v_mov_b32 v8, v32
    v_mov_b32 v9, v33
    v_mov_b32 v10, v34
    v_mov_b32 v12, v36
    v_mov_b32 v13, v37
    v_mov_b32 v14, v38
    v_cmp_ne_u32 vcc, 0, v24
    s_nop 0
    s_cmp_eq_u64 vcc, 0
    s_cbranch_scc1 L_Agot
    buffer_load_dwordx4 v[32:35], v7, s[48:51], s80 offen sc1
    buffer_load_dwordx4 v[36:39], v7, s[48:51], s80 offen offset:1024 sc1
    s_waitcnt vmcnt(6)
    v_subrev_u32 v24, s8, v42
    v_subrev_u32 v25, s8, v46
    v_or_b32 v24, v24, v25
    v_lshrrev_b32 v24, 4, v24
    v_xor_b32 v25, s9, v43
    v_xor_b32 v26, s9, v47
    v_or3_b32 v24, v24, v25, v26
    v_mov_b32 v8, v40
    v_mov_b32 v9, v41
    v_mov_b32 v10, v42
    v_mov_b32 v12, v44
    v_mov_b32 v13, v45
    v_mov_b32 v14, v46
    v_cmp_ne_u32 vcc, 0, v24
    s_nop 0
    s_cmp_eq_u64 vcc, 0
    s_cbranch_scc1 L_Agot
    buffer_load_dwordx4 v[40:43], v7, s[48:51], s80 offen sc1
    buffer_load_dwordx4 v[44:47], v7, s[48:51], s80 offen offset:1024 sc1
    s_waitcnt vmcnt(6)
    v_subrev_u32 v24, s8, v50
    v_subrev_u32 v25, s8, v54
    v_or_b32 v24, v24, v25
    v_lshrrev_b32 v24, 4, v24
    v_xor_b32 v25, s9, v51
    v_xor_b32 v26, s9, v55
    v_or3_b32 v24, v24, v25, v26
    v_mov_b32 v8, v48
    v_mov_b32 v9, v49
    v_mov_b32 v10, v50
    v_mov_b32 v12, v52
    v_mov_b32 v13, v53
    v_mov_b32 v14, v54
    v_cmp_ne_u32 vcc, 0, v24
    s_nop 0
    s_cmp_eq_u64 vcc, 0
    s_cbranch_scc1 L_Agot
    buffer_load_dwordx4 v[48:51], v7, s[48:51], s80 offen sc1
    buffer_load_dwordx4 v[52:55], v7, s[48:51], s80 offen offset:1024 sc1
    s_waitcnt vmcnt(6)
    v_subrev_u32 v24, s8, v58
    v_subrev_u32 v25, s8, v62
    v_or_b32 v24, v24, v25
    v_lshrrev_b32 v24, 4, v24
    v_xor_b32 v25, s9, v59
    v_xor_b32 v26, s9, v63
    v_or3_b32 v24, v24, v25, v26
    v_mov_b32 v8, v56
    v_mov_b32 v9, v57
    v_mov_b32 v10, v58
    v_mov_b32 v12, v60
    v_mov_b32 v13, v61
    v_mov_b32 v14, v62
    v_cmp_ne_u32 vcc, 0, v24
    s_nop 0
    s_cmp_eq_u64 vcc, 0
    s_cbranch_scc1 L_Agot
    buffer_load_dwordx4 v[56:59], v7, s[48:51], s80 offen sc1
    buffer_load_dwordx4 v[60:63], v7, s[48:51], s80 offen offset:1024 sc1
    s_branch L_Aring
L_Agot:
    ds_write_b16 v4, v8 offset:0
    ds_write_b16_d16_hi v4, v8 offset:8
    ds_write_b16 v4, v9 offset:16
    ds_write_b16_d16_hi v4, v9 offset:24
    ds_write_b16 v4, v12 offset:576
    ds_write_b16_d16_hi v4, v12 offset:584
    ds_write_b16 v4, v13 offset:592
    ds_write_b16_d16_hi v4, v13 offset:600
    v_cmp_ne_u32 vcc, s93, v10
    v_cmp_ne_u32 s[64:65], s93, v14
    s_nop 0
    s_or_b64 vcc, vcc, s[64:65]
    s_or_b32 s15, vcc_lo, vcc_hi
    v_mov_b32 v17, s15
    ds_write_b64 v97, v[16:17]
    s_waitcnt lgkmcnt(0)
    s_branch L_fin
L_A2:
    s_load_dwordx2 s[46:47], s[44:45], 0
    v_and_b32 v3, 3, v1
    v_lshlrev_b32 v3, 2, v3
    v_lshrrev_b32 v4, 2, v1
    v_add_u32 v3, v3, v4
    v_lshlrev_b32 v3, 8, v3
    v_xor_b32 v4, v2, v1
    v_lshl_or_b32 v3, v4, 4, v3
    s_lshl_b32 s13, s3, 13
    v_add_u32 v3, s13, v3
    v_xor_b32 v4, 64, v3
    v_xor_b32 v5, 0x80, v3
    v_xor_b32 v6, 0xc0, v3
    v_and_b32 v99, 3, v0
    v_lshlrev_b32 v98, 6, v99
    s_lshl_b32 s15, s3, 2
    s_add_u32 s15, s15, 107776
    v_add_u32 v98, s15, v98
    v_mul_u32_u24 v96, 288, v99
    v_lshl_add_u32 v96, v2, 4, v96
    v_add_u32 v96, 106496, v96
    v_mul_u32_u24 v120, 544, v99
    v_lshl_add_u32 v120, v2, 7, v120
    v_bfe_u32 v99, v0, 2, 2
    v_lshl_add_u32 v120, v99, 4, v120
    v_add_u32 v120, s13, v120
    v_mov_b32 v104, 0
    v_mov_b32 v105, 0
    v_mov_b32 v106, 0
    v_mov_b32 v107, 0
    v_mov_b32 v108, 0
    v_mov_b32 v109, 0
    v_mov_b32 v110, 0
    v_mov_b32 v111, 0
    v_mov_b32 v112, 0
    v_mov_b32 v113, 0
    v_mov_b32 v114, 0
    v_mov_b32 v115, 0
    v_mov_b32 v116, 0
    v_mov_b32 v117, 0
    v_mov_b32 v118, 0
    v_mov_b32 v119, 0
    v_lshlrev_b32 v126, 3, v0
    s_and_b32 s13, s3, 3
    s_mul_i32 s15, s13, 544
    v_add_u32 v121, s15, v126
    v_add_u32 v123, 0x10000, v121
    s_lshl_b32 s15, s13, 6
    s_add_u32 s15, s15, 108544
    v_mov_b32 v122, s15
    s_mul_i32 s60, s4, 49152
    s_lshl2_add_u32 s15, s11, s10
    s_mul_i32 s15, s15, 2176
    s_add_u32 s60, s60, s15
    s_add_u32 s60, s60, 0xa0000
    s_lshl_b32 s15, s13, 9
    s_add_u32 s60, s60, s15
    s_waitcnt vmcnt(0)
    ds_write_b32 v125, v124 offset:32
    s_waitcnt lgkmcnt(0)
    s_mul_i32 s8, s46, 1664525
    s_add_u32 s8, s8, 1013904223
    s_mul_i32 s9, s47, 22695477
    s_add_u32 s9, s9, 1
    s_mov_b32 s62, 2
    s_mov_b32 s14, 0
L_Agp:
    ds_read_b32 v100, v125 offset:48
    ds_read_b32 v101, v97
    s_add_u32 s14, s14, 1
    s_cmp_gt_u32 s14, 4194304
    s_cbranch_scc1 L_end
    s_waitcnt lgkmcnt(0)
    v_readfirstlane_b32 s15, v100
    v_readfirstlane_b32 s63, v101
    s_nop 0
    s_or_b32 s63, s63, s15
    s_cmp_eq_u32 s63, 0
    s_cbranch_scc0 L_Agp_ok
    s_sleep 1
    s_branch L_Agp
L_Agp_ok:
    s_cmp_eq_u32 s15, 0
    s_cbranch_scc1 L_Alate
    s_mov_b32 s62, 0
L_Avg:
    s_mov_b32 s14, 0
L_Agv:
    ds_read_b32 v100, v125 offset:52
    s_add_u32 s14, s14, 1
    s_cmp_gt_u32 s14, 4194304
    s_cbranch_scc1 L_end
    s_waitcnt lgkmcnt(0)
    v_readfirstlane_b32 s15, v100
    s_nop 0
    s_cmp_eq_u32 s15, 0
    s_cbranch_scc0 L_Agv_ok
    s_sleep 1
    s_branch L_Agv
L_Agv_ok:
    s_mov_b32 s14, 0
L_Atv:
    ds_read_b32 v100, v125 offset:368
    s_add_u32 s14, s14, 1
    s_cmp_gt_u32 s14, 4194304
    s_cbranch_scc1 L_end
    s_waitcnt lgkmcnt(0)
    v_readfirstlane_b32 s15, v100
    s_nop 0
    s_cmp_eq_u32 s15, 0
    s_cbranch_scc0 L_Atv_ok
    s_branch L_Atv
L_Atv_ok:
    buffer_load_dwordx4 v[8:11], v7, s[56:59], s72 offen nt
    buffer_load_dwordx4 v[12:15], v7, s[56:59], s73 offen nt
    buffer_load_dwordx4 v[16:19], v7, s[56:59], s74 offen nt
    buffer_load_dwordx4 v[20:23], v7, s[56:59], s75 offen nt
    buffer_load_dwordx4 v[24:27], v7, s[56:59], s76 offen nt
    ds_write_b32 v125, v124 offset:372
    buffer_load_dwordx4 v[28:31], v7, s[56:59], s77 offen nt
    buffer_load_dwordx4 v[32:35], v7, s[56:59], s78 offen nt
    buffer_load_dwordx4 v[36:39], v7, s[56:59], s79 offen nt
    s_cmp_eq_u32 s62, 2
    s_cbranch_scc1 L_Avp
    ds_read_b32 v100, v97
    s_waitcnt lgkmcnt(0)
    v_readfirstlane_b32 s62, v100
    s_cmp_ge_u32 s3, 7
    s_cselect_b32 s62, 1, s62
    s_cmp_lg_u32 s62, 0
    s_cbranch_scc1 L_Alate
    s_waitcnt vmcnt(6)
    v_perm_b32 v40, v12, v8, s6
    v_perm_b32 v44, v12, v8, s7
    v_perm_b32 v48, v13, v9, s6
    v_perm_b32 v52, v13, v9, s7
    v_perm_b32 v56, v14, v10, s6
    v_perm_b32 v60, v14, v10, s7
    v_perm_b32 v64, v15, v11, s6
    v_perm_b32 v68, v15, v11, s7
    s_waitcnt vmcnt(4)
    v_perm_b32 v41, v20, v16, s6
    v_perm_b32 v45, v20, v16, s7
    v_perm_b32 v49, v21, v17, s6
    v_perm_b32 v53, v21, v17, s7
    v_perm_b32 v57, v22, v18, s6
    v_perm_b32 v61, v22, v18, s7
    v_perm_b32 v65, v23, v19, s6
    v_perm_b32 v69, v23, v19, s7
    s_waitcnt vmcnt(2)
    v_perm_b32 v42, v28, v24, s6
    v_perm_b32 v46, v28, v24, s7
    v_perm_b32 v50, v29, v25, s6
    v_perm_b32 v54, v29, v25, s7
    v_perm_b32 v58, v30, v26, s6
    v_perm_b32 v62, v30, v26, s7
    v_perm_b32 v66, v31, v27, s6
    v_perm_b32 v70, v31, v27, s7
    s_waitcnt vmcnt(0)
    ds_write_b32 v125, v124 offset:84
    v_perm_b32 v43, v36, v32, s6
    v_perm_b32 v47, v36, v32, s7
    v_perm_b32 v51, v37, v33, s6
    v_perm_b32 v55, v37, v33, s7
    v_perm_b32 v59, v38, v34, s6
    v_perm_b32 v63, v38, v34, s7
    v_perm_b32 v67, v39, v35, s6
    v_perm_b32 v71, v39, v35, s7
    ds_read_b128 v[8:11], v3 offset:0
    ds_read_b128 v[12:15], v4 offset:0
    ds_read_b128 v[16:19], v5 offset:0
    ds_read_b128 v[20:23], v6 offset:0
    ds_read_b128 v[24:27], v3 offset:4096
    ds_read_b128 v[28:31], v4 offset:4096
    ds_read_b128 v[32:35], v5 offset:4096
    ds_read_b128 v[36:39], v6 offset:4096
    s_mov_b32 s14, 0
L_Aq1:
    ds_read_b64 v[100:101], v97
    s_add_u32 s14, s14, 1
    s_cmp_gt_u32 s14, 4194304
    s_cbranch_scc1 L_end
    s_waitcnt lgkmcnt(0)
    v_readfirstlane_b32 s15, v100
    v_readfirstlane_b32 s61, v101
    s_cmp_eq_u32 s15, 0
    s_cbranch_scc0 L_Aq1_ok
    s_sleep 1
    s_branch L_Aq1
L_Aq1_ok:
    ds_read_b128 v[72:75], v96 offset:0
    ds_read_b128 v[76:79], v96 offset:64
    ds_read_b128 v[80:83], v96 offset:128
    ds_read_b128 v[84:87], v96 offset:192
    s_waitcnt lgkmcnt(3)
    v_mfma_f32_16x16x32_bf16 v[88:91], v[8:11], v[72:75], 0
    v_mfma_f32_16x16x32_bf16 v[92:95], v[24:27], v[72:75], 0
    s_waitcnt lgkmcnt(2)
    v_mfma_f32_16x16x32_bf16 v[88:91], v[12:15], v[76:79], v[88:91]
    v_mfma_f32_16x16x32_bf16 v[92:95], v[28:31], v[76:79], v[92:95]
    s_waitcnt lgkmcnt(1)
    v_mfma_f32_16x16x32_bf16 v[88:91], v[16:19], v[80:83], v[88:91]
    v_mfma_f32_16x16x32_bf16 v[92:95], v[32:35], v[80:83], v[92:95]
    s_waitcnt lgkmcnt(0)
    v_mfma_f32_16x16x32_bf16 v[88:91], v[20:23], v[84:87], v[88:91]
    v_mfma_f32_16x16x32_bf16 v[92:95], v[36:39], v[84:87], v[92:95]
    s_nop 7
    s_branch L_Asm
L_Alate:
    ds_read_b128 v[40:43], v3 offset:0
    ds_read_b128 v[44:47], v4 offset:0
    ds_read_b128 v[48:51], v5 offset:0
    ds_read_b128 v[52:55], v6 offset:0
    ds_read_b128 v[56:59], v3 offset:4096
    ds_read_b128 v[60:63], v4 offset:4096
    ds_read_b128 v[64:67], v5 offset:4096
    ds_read_b128 v[68:71], v6 offset:4096
    s_mov_b32 s14, 0
L_Aq2:
    ds_read_b64 v[100:101], v97
    s_add_u32 s14, s14, 1
    s_cmp_gt_u32 s14, 4194304
    s_cbranch_scc1 L_end
    s_waitcnt lgkmcnt(0)
    v_readfirstlane_b32 s15, v100
    v_readfirstlane_b32 s61, v101
    s_cmp_eq_u32 s15, 0
    s_cbranch_scc0 L_Aq2_ok
    s_sleep 1
    s_branch L_Aq2
L_Aq2_ok:
    ds_read_b128 v[72:75], v96 offset:0
    ds_read_b128 v[76:79], v96 offset:64
    ds_read_b128 v[80:83], v96 offset:128
    ds_read_b128 v[84:87], v96 offset:192
    s_waitcnt lgkmcnt(3)
    v_mfma_f32_16x16x32_bf16 v[88:91], v[40:43], v[72:75], 0
    v_mfma_f32_16x16x32_bf16 v[92:95], v[56:59], v[72:75], 0
    s_waitcnt lgkmcnt(2)
    v_mfma_f32_16x16x32_bf16 v[88:91], v[44:47], v[76:79], v[88:91]
    v_mfma_f32_16x16x32_bf16 v[92:95], v[60:63], v[76:79], v[92:95]
    s_waitcnt lgkmcnt(1)
    v_mfma_f32_16x16x32_bf16 v[88:91], v[48:51], v[80:83], v[88:91]
    v_mfma_f32_16x16x32_bf16 v[92:95], v[64:67], v[80:83], v[92:95]
    s_waitcnt lgkmcnt(0)
    v_mfma_f32_16x16x32_bf16 v[88:91], v[52:55], v[84:87], v[88:91]
    v_mfma_f32_16x16x32_bf16 v[92:95], v[68:71], v[84:87], v[92:95]
L_Asm:
    s_nop 6
    v_mov_b32_dpp v88, v90 quad_perm:[0,1,2,3] row_mask:0xf bank_mask:0x2
    v_mov_b32_dpp v89, v91 quad_perm:[0,1,2,3] row_mask:0xf bank_mask:0x2
    s_nop 0
    v_mov_b32_dpp v88, v92 quad_perm:[0,1,2,3] row_mask:0xf bank_mask:0x4
    v_mov_b32_dpp v89, v93 quad_perm:[0,1,2,3] row_mask:0xf bank_mask:0x4
    s_nop 0
    v_mov_b32_dpp v88, v94 quad_perm:[0,1,2,3] row_mask:0xf bank_mask:0x8
    v_mov_b32_dpp v89, v95 quad_perm:[0,1,2,3] row_mask:0xf bank_mask:0x8
    v_cvt_pk_bf16_f32 v100, v88, v89
    v_lshlrev_b32 v88, 16, v100
    v_and_b32 v89, 0xffff0000, v100
    v_mul_f32 v88, 0x3db504f3, v88
    v_mul_f32 v89, 0x3db504f3, v89
    v_cvt_pk_bf16_f32 v100, v88, v89
    v_lshlrev_b32 v88, 16, v100
    v_and_b32 v89, 0xffff0000, v100
    v_max_f32 v99, v88, v89
    s_nop 1
    v_max_f32_dpp v99, v99, v99 row_ror:4 row_mask:0xf bank_mask:0xf
    s_nop 1
    v_max_f32_dpp v99, v99, v99 row_ror:8 row_mask:0xf bank_mask:0xf
    v_mov_b32 v100, v99
    s_nop 1
    v_permlane16_swap_b32 v99, v100
    v_max_f32 v99, v99, v100
    v_mov_b32 v100, v99
    s_nop 1
    v_permlane32_swap_b32 v99, v100
    v_max_f32 v99, v99, v100
    ds_write_b32 v98, v99
    v_sub_f32 v88, v88, v99
    v_sub_f32 v89, v89, v99
    v_mul_f32 v88, 0x3fb8aa3b, v88
    v_mul_f32 v89, 0x3fb8aa3b, v89
    v_exp_f32 v88, v88
    v_exp_f32 v89, v89
    s_nop 0
    v_add_f32 v100, v88, v89
    v_cvt_pk_bf16_f32 v102, v88, v89
    s_nop 0
    v_add_f32_dpp v100, v100, v100 row_ror:4 row_mask:0xf bank_mask:0xf
    s_nop 1
    v_add_f32_dpp v100, v100, v100 row_ror:8 row_mask:0xf bank_mask:0xf
    v_mov_b32 v101, v100
    s_nop 1
    v_permlane16_swap_b32 v100, v101
    v_add_f32 v100, v100, v101
    v_mov_b32 v101, v100
    s_nop 1
    v_permlane32_swap_b32 v100, v101
    v_add_f32 v100, v100, v101
    ds_write_b32 v98, v100 offset:256
    ds_write_b32 v125, v124 offset:160
    v_mov_b32_dpp v104, v102 quad_perm:[0,1,2,3] row_mask:0xf bank_mask:0x1
    v_mov_b32_dpp v105, v102 row_ror:12 row_mask:0xf bank_mask:0x1
    v_mov_b32_dpp v106, v102 row_ror:8 row_mask:0xf bank_mask:0x1
    v_mov_b32_dpp v107, v102 row_ror:4 row_mask:0xf bank_mask:0x1
    v_mov_b32_dpp v108, v102 row_ror:4 row_mask:0xf bank_mask:0x2
    v_mov_b32_dpp v109, v102 quad_perm:[0,1,2,3] row_mask:0xf bank_mask:0x2
    v_mov_b32_dpp v110, v102 row_ror:12 row_mask:0xf bank_mask:0x2
    v_mov_b32_dpp v111, v102 row_ror:8 row_mask:0xf bank_mask:0x2
    v_mov_b32_dpp v112, v102 row_ror:8 row_mask:0xf bank_mask:0x4
    v_mov_b32_dpp v113, v102 row_ror:4 row_mask:0xf bank_mask:0x4
    v_mov_b32_dpp v114, v102 quad_perm:[0,1,2,3] row_mask:0xf bank_mask:0x4
    v_mov_b32_dpp v115, v102 row_ror:12 row_mask:0xf bank_mask:0x4
    v_mov_b32_dpp v116, v102 row_ror:12 row_mask:0xf bank_mask:0x8
    v_mov_b32_dpp v117, v102 row_ror:8 row_mask:0xf bank_mask:0x8
    v_mov_b32_dpp v118, v102 row_ror:4 row_mask:0xf bank_mask:0x8
    v_mov_b32_dpp v119, v102 quad_perm:[0,1,2,3] row_mask:0xf bank_mask:0x8
    s_cmp_eq_u32 s62, 0
    s_cbranch_scc1 L_Apv
    s_cmp_eq_u32 s62, 2
    s_cbranch_scc1 L_Avg
L_Avp:
    s_waitcnt vmcnt(6)
    v_perm_b32 v40, v12, v8, s6
    v_perm_b32 v44, v12, v8, s7
    v_perm_b32 v48, v13, v9, s6
    v_perm_b32 v52, v13, v9, s7
    v_perm_b32 v56, v14, v10, s6
    v_perm_b32 v60, v14, v10, s7
    v_perm_b32 v64, v15, v11, s6
    v_perm_b32 v68, v15, v11, s7
    s_waitcnt vmcnt(4)
    v_perm_b32 v41, v20, v16, s6
    v_perm_b32 v45, v20, v16, s7
    v_perm_b32 v49, v21, v17, s6
    v_perm_b32 v53, v21, v17, s7
    v_perm_b32 v57, v22, v18, s6
    v_perm_b32 v61, v22, v18, s7
    v_perm_b32 v65, v23, v19, s6
    v_perm_b32 v69, v23, v19, s7
    s_waitcnt vmcnt(2)
    v_perm_b32 v42, v28, v24, s6
    v_perm_b32 v46, v28, v24, s7
    v_perm_b32 v50, v29, v25, s6
    v_perm_b32 v54, v29, v25, s7
    v_perm_b32 v58, v30, v26, s6
    v_perm_b32 v62, v30, v26, s7
    v_perm_b32 v66, v31, v27, s6
    v_perm_b32 v70, v31, v27, s7
    s_waitcnt vmcnt(0)
    ds_write_b32 v125, v124 offset:84
    v_perm_b32 v43, v36, v32, s6
    v_perm_b32 v47, v36, v32, s7
    v_perm_b32 v51, v37, v33, s6
    v_perm_b32 v55, v37, v33, s7
    v_perm_b32 v59, v38, v34, s6
    v_perm_b32 v63, v38, v34, s7
    v_perm_b32 v67, v39, v35, s6
    v_perm_b32 v71, v39, v35, s7
L_Apv:
    s_nop 1
    v_mfma_f32_16x16x32_bf16 v[88:91], v[40:43], v[104:107], 0
    v_mfma_f32_16x16x32_bf16 v[92:95], v[56:59], v[104:107], 0
    v_mfma_f32_16x16x32_bf16 v[88:91], v[44:47], v[108:111], v[88:91]
    v_mfma_f32_16x16x32_bf16 v[92:95], v[60:63], v[108:111], v[92:95]
    v_mfma_f32_16x16x32_bf16 v[88:91], v[48:51], v[112:115], v[88:91]
    v_mfma_f32_16x16x32_bf16 v[92:95], v[64:67], v[112:115], v[92:95]
    v_mfma_f32_16x16x32_bf16 v[88:91], v[52:55], v[116:119], v[88:91]
    v_mfma_f32_16x16x32_bf16 v[92:95], v[68:71], v[116:119], v[92:95]
    s_nop 6
    ds_write_b128 v120, v[88:91]
    ds_write_b128 v120, v[92:95] offset:64
    s_cmp_ge_u32 s3, 4
    s_cbranch_scc1 L_Ab3
    s_mov_b32 s14, 0
L_Agf:
    ds_read_b32 v100, v97 offset:468
    s_add_u32 s14, s14, 1
    s_cmp_gt_u32 s14, 4194304
    s_cbranch_scc1 L_end
    s_waitcnt lgkmcnt(0)
    v_readfirstlane_b32 s15, v100
    s_nop 0
    s_cmp_eq_u32 s15, 0
    s_cbranch_scc0 L_Agf_ok
    s_sleep 1
    s_branch L_Agf
L_Agf_ok:
    s_branch L_Fld
L_Ab3:
    s_waitcnt lgkmcnt(0)
    s_barrier
    s_cmp_ge_u32 s3, 8
    s_cbranch_scc1 L_fin
    ds_read_b128 v[56:59], v122 offset:0
    ds_read_b128 v[60:63], v122 offset:16
    ds_read_b128 v[64:67], v122 offset:32
    ds_read_b128 v[68:71], v122 offset:48
    ds_read_b64 v[8:9], v121 offset:0
    ds_read_b64 v[10:11], v121 offset:8192
    ds_read_b64 v[12:13], v121 offset:16384
    ds_read_b64 v[14:15], v121 offset:24576
    ds_read_b64 v[16:17], v121 offset:32768
    ds_read_b64 v[18:19], v121 offset:40960
    ds_read_b64 v[20:21], v121 offset:49152
    ds_read_b64 v[22:23], v121 offset:57344
    ds_read_b64 v[24:25], v123 offset:0
    ds_read_b64 v[26:27], v123 offset:8192
    ds_read_b64 v[28:29], v123 offset:16384
    ds_read_b64 v[30:31], v123 offset:24576
    ds_read_b64 v[32:33], v123 offset:32768
    s_waitcnt lgkmcnt(9)
    v_pk_mul_f32 v[72:73], v[8:9], v[56:57] op_sel_hi:[1,0]
    v_pk_mul_f32 v[74:75], v[10:11], v[56:57] op_sel:[0,1] op_sel_hi:[1,1]
    v_pk_mul_f32 v[76:77], v[12:13], v[58:59] op_sel_hi:[1,0]
    v_pk_fma_f32 v[72:73], v[14:15], v[58:59], v[72:73] op_sel:[0,1,0] op_sel_hi:[1,1,1]
    s_waitcnt lgkmcnt(5)
    v_pk_fma_f32 v[74:75], v[16:17], v[60:61], v[74:75] op_sel_hi:[1,0,1]
    v_pk_fma_f32 v[76:77], v[18:19], v[60:61], v[76:77] op_sel:[0,1,0] op_sel_hi:[1,1,1]
    v_pk_fma_f32 v[72:73], v[20:21], v[62:63], v[72:73] op_sel_hi:[1,0,1]
    v_pk_fma_f32 v[74:75], v[22:23], v[62:63], v[74:75] op_sel:[0,1,0] op_sel_hi:[1,1,1]
    s_waitcnt lgkmcnt(2)
    v_pk_fma_f32 v[76:77], v[24:25], v[64:65], v[76:77] op_sel_hi:[1,0,1]
    v_pk_fma_f32 v[72:73], v[26:27], v[64:65], v[72:73] op_sel:[0,1,0] op_sel_hi:[1,1,1]
    v_pk_fma_f32 v[74:75], v[28:29], v[66:67], v[74:75] op_sel_hi:[1,0,1]
    s_waitcnt lgkmcnt(0)
    v_pk_fma_f32 v[76:77], v[30:31], v[66:67], v[76:77] op_sel:[0,1,0] op_sel_hi:[1,1,1]
    v_pk_fma_f32 v[72:73], v[32:33], v[68:69], v[72:73] op_sel_hi:[1,0,1]
    v_pk_add_f32 v[72:73], v[72:73], v[74:75]
    v_pk_add_f32 v[72:73], v[72:73], v[76:77]
    v_min_u32 v72, -2, v72
    v_min_u32 v73, -2, v73
    s_cmp_lg_u32 s61, 0
    s_cbranch_scc1 L_far_14
    buffer_store_dwordx2 v[72:73], v126, s[48:51], s60 offen
    s_branch L_st_15
L_far_14:
    buffer_store_dwordx2 v[72:73], v126, s[48:51], s60 offen sc1
L_st_15:
    s_barrier
    s_branch L_Fld
L_Fld:
    s_and_b32 s61, s3, 3
    s_lshr_b32 s62, s3, 3
    s_bitcmp1_b32 s3, 2
    s_cbranch_scc1 L_F2
    s_mov_b32 s52, s28
    s_mov_b32 s53, s29
    s_mov_b32 s54, 0x1c0000
    s_mov_b32 s55, 0x20000
    v_bfe_u32 v6, v0, 2, 2
    s_lshl_b32 s63, s61, 1
    s_add_u32 s63, s63, s62
    s_mul_i32 s14, s63, 229376
    s_lshl_b32 s15, s12, 6
    s_add_u32 s64, s14, s15
    s_lshl_b32 s15, s63, 8
    s_add_u32 s15, s15, 114944
    s_cmp_eq_u32 s11, 7
    s_cbranch_scc1 L_Fl1g
    v_lshrrev_b32 v4, 2, v1
    v_and_b32 v3, 3, v0
    v_mov_b32 v125, v3
    v_lshl_add_u32 v124, v2, 7, s15
    s_mov_b32 s92, 0x22221111
    s_mov_b32 s93, 0x88884444
    s_branch L_Fl1c
L_Fl1g:
    v_lshrrev_b32 v4, 3, v1
    v_and_b32 v3, 7, v0
    v_and_b32 v125, 1, v0
    v_and_b32 v124, 1, v2
    v_lshl_add_u32 v124, v124, 11, s15
    v_lshrrev_b32 v123, 5, v0
    v_lshl_add_u32 v124, v123, 7, v124
    s_mov_b32 s92, 0x11111111
    s_mov_b32 s93, 0x22222222
L_Fl1c:
    v_and_b32 v5, 1, v2
    v_lshl_add_u32 v5, v4, 4, v5
    v_lshrrev_b32 v4, 5, v0
    v_lshl_add_u32 v5, v4, 3, v5
    v_mul_u32_u24 v5, 7168, v5
    v_lshl_add_u32 v112, v3, 4, v5
    s_cmp_lg_u32 s11, 7
    s_cbranch_scc1 L_Fl1d
    s_add_u32 s65, s64, 14336
    s_add_u32 s66, s64, 28672
    s_add_u32 s67, s64, 43008
    buffer_load_dwordx4 v[8:11], v112, s[52:55], s64 offen
    buffer_load_dwordx4 v[12:15], v112, s[52:55], s65 offen
    buffer_load_dwordx4 v[16:19], v112, s[52:55], s66 offen
    buffer_load_dwordx4 v[20:23], v112, s[52:55], s67 offen
    buffer_load_dwordx4 v[24:27], v112, s[52:55], s64 offen offset:3584
    buffer_load_dwordx4 v[28:31], v112, s[52:55], s65 offen offset:3584
    buffer_load_dwordx4 v[32:35], v112, s[52:55], s66 offen offset:3584
    buffer_load_dwordx4 v[36:39], v112, s[52:55], s67 offen offset:3584
    s_mov_b32 s15, 0x1c0008
    v_lshlrev_b32 v5, 8, v0
    s_mov_b32 s14, 0
    s_mov_b32 exec_lo, 0xffffffff
    s_mov_b32 exec_hi, 0x0
L_gate_16:
    buffer_load_dwordx2 v[96:97], v5, s[48:51], s15 offen sc1
    s_add_u32 s14, s14, 1
    s_cmp_gt_u32 s14, 1048576
    s_cbranch_scc1 L_end
    s_waitcnt vmcnt(0)
    v_cmp_eq_u64 vcc, s[8:9], v[96:97]
    s_nop 0
    s_bcnt1_i32_b64 s13, vcc
    s_cmp_lt_u32 s13, 32
    s_cbranch_scc1 L_gate_16
    s_mov_b64 exec, -1
L_Fl1d:
    s_mov_b32 s56, s16
    s_mov_b32 s57, s17
    s_mov_b32 s58, 0x1000
    s_mov_b32 s59, 0x20000
    v_and_b32 v3, 31, v0
    v_lshrrev_b32 v5, 5, v0
    v_lshl_add_u32 v120, v3, 1, v5
    s_lshl_b32 s15, s61, 6
    v_add_u32 v120, s15, v120
    v_and_b32 v4, 3, v0
    v_lshl_add_u32 v4, v5, 3, v4
    v_lshrrev_b32 v113, 3, v120
    v_lshl_add_u32 v4, v113, 4, v4
    v_lshlrev_b32 v4, 1, v4
    s_lshl_b32 s15, s10, 10
    buffer_load_ushort v114, v4, s[56:59], s15 offen
    buffer_load_ushort v115, v4, s[56:59], s15 offen offset:8
    v_lshlrev_b32 v113, 4, v3
    v_lshl_add_u32 v113, v5, 11, v113
    s_lshl_b32 s14, s10, 12
    s_lshl_b32 s15, s61, 9
    s_add_u32 s14, s14, s15
    s_add_u32 s80, s14, 0x10000
    s_add_u32 s81, s80, 16384
    s_add_u32 s82, s80, 32768
    s_add_u32 s83, s80, 49152
    buffer_load_dwordx4 v[100:103], v113, s[48:51], s80 offen sc1
    buffer_load_dwordx4 v[72:75], v113, s[48:51], s81 offen sc1
    buffer_load_dwordx4 v[104:107], v113, s[48:51], s82 offen sc1
    buffer_load_dwordx4 v[108:111], v113, s[48:51], s83 offen sc1
    v_lshl_add_u32 v124, v6, 4, v124
    s_lshl_b32 s14, s62, 10
    s_add_u32 s14, s14, 128256
    s_lshl_b32 s15, s63, 7
    s_add_u32 s15, s15, s14
    v_lshl_add_u32 v4, v125, 6, s15
    v_lshl_add_u32 v4, v2, 4, v4
    v_mov_b32 v5, 108288
    s_mov_b32 vcc_lo, 0xf000f
    s_mov_b32 vcc_hi, 0xf000f
    v_cndmask_b32 v116, v5, v4, vcc
    s_mov_b32 vcc_lo, 0xf000f0
    s_mov_b32 vcc_hi, 0xf000f0
    v_cndmask_b32 v117, v5, v4, vcc
    s_mov_b32 vcc_lo, 0xf000f00
    s_mov_b32 vcc_hi, 0xf000f00
    v_cndmask_b32 v118, v5, v4, vcc
    s_mov_b32 vcc_lo, 0xf000f000
    s_mov_b32 vcc_hi, 0xf000f000
    v_cndmask_b32 v119, v5, v4, vcc
    v_lshl_add_u32 v122, v120, 2, s14
    v_lshlrev_b32 v121, 3, v120
    v_add_u32 v121, 110848, v121
    s_lshl_b32 s15, s61, 4
    s_add_u32 s15, s15, 110592
    v_mov_b32 v123, s15
    s_lshl_b32 s14, s10, 14
    s_lshl_b32 s15, s61, 9
    s_add_u32 s14, s14, s15
    s_add_u32 s84, s14, 0x20000
    s_add_u32 s85, s84, 4096
    s_add_u32 s86, s84, 8192
    s_add_u32 s87, s84, 12288
    s_cmp_eq_u32 s11, 7
    s_cbranch_scc1 L_Fl1e
    s_barrier
    s_barrier
    s_add_u32 s65, s64, 14336
    s_add_u32 s66, s64, 28672
    s_add_u32 s67, s64, 43008
    buffer_load_dwordx4 v[8:11], v112, s[52:55], s64 offen
    buffer_load_dwordx4 v[12:15], v112, s[52:55], s65 offen
    buffer_load_dwordx4 v[16:19], v112, s[52:55], s66 offen
    buffer_load_dwordx4 v[20:23], v112, s[52:55], s67 offen
    buffer_load_dwordx4 v[24:27], v112, s[52:55], s64 offen offset:3584
    buffer_load_dwordx4 v[28:31], v112, s[52:55], s65 offen offset:3584
    buffer_load_dwordx4 v[32:35], v112, s[52:55], s66 offen offset:3584
    buffer_load_dwordx4 v[36:39], v112, s[52:55], s67 offen offset:3584
    s_branch L_Fl1f
L_Fl1e:
    s_waitcnt vmcnt(0)
L_Fl1f:
    s_mov_b32 s14, 0
    s_waitcnt vmcnt(11)
    v_max3_u32 v5, v100, v101, v102
    v_max_u32 v5, v5, v103
    v_cmp_eq_u32 s[64:65], -1, v5
    s_waitcnt vmcnt(10)
    v_max3_u32 v5, v72, v73, v74
    v_max_u32 v5, v5, v75
    v_cmp_eq_u32 s[66:67], -1, v5
    s_waitcnt vmcnt(9)
    v_max3_u32 v5, v104, v105, v106
    v_max_u32 v5, v5, v107
    v_cmp_eq_u32 s[68:69], -1, v5
    s_waitcnt vmcnt(8)
    v_max3_u32 v5, v108, v109, v110
    v_max_u32 v5, v5, v111
    v_cmp_eq_u32 s[70:71], -1, v5
    s_or_b64 s[46:47], s[64:65], s[66:67]
    s_or_b64 s[46:47], s[46:47], s[68:69]
    s_or_b64 s[46:47], s[46:47], s[70:71]
    s_cbranch_scc0 L_poll_17_d
L_poll_17:
    s_sleep 2
    s_mov_b64 exec, s[64:65]
    buffer_load_dwordx4 v[100:103], v113, s[48:51], s80 offen sc1
    s_mov_b64 exec, s[66:67]
    buffer_load_dwordx4 v[72:75], v113, s[48:51], s81 offen sc1
    s_mov_b64 exec, s[68:69]
    buffer_load_dwordx4 v[104:107], v113, s[48:51], s82 offen sc1
    s_mov_b64 exec, s[70:71]
    buffer_load_dwordx4 v[108:111], v113, s[48:51], s83 offen sc1
    s_add_u32 s14, s14, 1
    s_cmp_gt_u32 s14, 1048576
    s_cbranch_scc1 L_end
    s_waitcnt vmcnt(3)
    s_mov_b64 exec, s[64:65]
    v_max3_u32 v5, v100, v101, v102
    v_max_u32 v5, v5, v103
    v_cmp_eq_u32 s[64:65], -1, v5
    s_waitcnt vmcnt(2)
    s_mov_b64 exec, s[66:67]
    v_max3_u32 v5, v72, v73, v74
    v_max_u32 v5, v5, v75
    v_cmp_eq_u32 s[66:67], -1, v5
    s_waitcnt vmcnt(1)
    s_mov_b64 exec, s[68:69]
    v_max3_u32 v5, v104, v105, v106
    v_max_u32 v5, v5, v107
    v_cmp_eq_u32 s[68:69], -1, v5
    s_waitcnt vmcnt(0)
    s_mov_b64 exec, s[70:71]
    v_max3_u32 v5, v108, v109, v110
    v_max_u32 v5, v5, v111
    v_cmp_eq_u32 s[70:71], -1, v5
    s_or_b64 s[46:47], s[64:65], s[66:67]
    s_or_b64 s[46:47], s[46:47], s[68:69]
    s_or_b64 s[46:47], s[46:47], s[70:71]
    s_cbranch_scc1 L_poll_17
    s_mov_b64 exec, -1
L_poll_17_d:
    v_permlane32_swap_b32 v100, v102
    v_permlane32_swap_b32 v101, v103
    v_permlane32_swap_b32 v72, v74
    v_permlane32_swap_b32 v73, v75
    v_permlane32_swap_b32 v104, v106
    v_permlane32_swap_b32 v105, v107
    v_permlane32_swap_b32 v108, v110
    v_permlane32_swap_b32 v109, v111
    v_pk_add_f32 v[100:101], v[100:101], v[102:103]
    v_cvt_pk_bf16_f32 v5, v100, v101
    v_lshlrev_b32 v100, 16, v5
    v_and_b32 v101, 0xffff0000, v5
    v_pk_add_f32 v[72:73], v[72:73], v[74:75]
    v_cvt_pk_bf16_f32 v5, v72, v73
    v_lshlrev_b32 v72, 16, v5
    v_and_b32 v73, 0xffff0000, v5
    v_pk_add_f32 v[104:105], v[104:105], v[106:107]
    v_cvt_pk_bf16_f32 v5, v104, v105
    v_lshlrev_b32 v104, 16, v5
    v_and_b32 v105, 0xffff0000, v5
    v_pk_add_f32 v[108:109], v[108:109], v[110:111]
    v_cvt_pk_bf16_f32 v5, v108, v109
    v_lshlrev_b32 v108, 16, v5
    v_and_b32 v109, 0xffff0000, v5
    v_lshlrev_b32 v114, 16, v114
    v_lshlrev_b32 v115, 16, v115
    v_add_f32 v104, 1.0, v104
    v_add_f32 v105, 1.0, v105
    v_cvt_pk_bf16_f32 v6, v104, v105
    v_lshlrev_b32 v104, 16, v6
    v_and_b32 v105, 0xffff0000, v6
    ds_write_b64 v121, v[108:109] offset:2048
    v_cvt_pk_bf16_f32 v5, v72, v73
    ds_write_b32 v122, v6
    ds_read_b128 v[76:79], v116
    ds_read_b128 v[80:83], v117
    ds_read_b128 v[84:87], v118
    ds_read_b128 v[88:91], v119
    ds_write_b32 v122, v5
    s_waitcnt vmcnt(6)
    v_perm_b32 v40, v12, v8, s6
    v_perm_b32 v44, v12, v8, s7
    v_perm_b32 v48, v13, v9, s6
    v_perm_b32 v52, v13, v9, s7
    v_perm_b32 v56, v14, v10, s6
    v_perm_b32 v60, v14, v10, s7
    v_perm_b32 v64, v15, v11, s6
    v_perm_b32 v68, v15, v11, s7
    s_waitcnt vmcnt(4)
    v_perm_b32 v41, v20, v16, s6
    v_perm_b32 v45, v20, v16, s7
    v_perm_b32 v49, v21, v17, s6
    v_perm_b32 v53, v21, v17, s7
    v_perm_b32 v57, v22, v18, s6
    v_perm_b32 v61, v22, v18, s7
    v_perm_b32 v65, v23, v19, s6
    v_perm_b32 v69, v23, v19, s7
    s_waitcnt vmcnt(2)
    v_perm_b32 v42, v28, v24, s6
    v_perm_b32 v46, v28, v24, s7
    v_perm_b32 v50, v29, v25, s6
    v_perm_b32 v54, v29, v25, s7
    v_perm_b32 v58, v30, v26, s6
    v_perm_b32 v62, v30, v26, s7
    v_perm_b32 v66, v31, v27, s6
    v_perm_b32 v70, v31, v27, s7
    s_waitcnt vmcnt(0)
    v_perm_b32 v43, v36, v32, s6
    v_perm_b32 v47, v36, v32, s7
    v_perm_b32 v51, v37, v33, s6
    v_perm_b32 v55, v37, v33, s7
    v_perm_b32 v59, v38, v34, s6
    v_perm_b32 v63, v38, v34, s7
    v_perm_b32 v67, v39, v35, s6
    v_perm_b32 v71, v39, v35, s7
    ds_read_b128 v[8:11], v116
    ds_read_b128 v[12:15], v117
    ds_read_b128 v[16:19], v118
    ds_read_b128 v[20:23], v119
    s_waitcnt lgkmcnt(4)
    v_mfma_f32_16x16x32_bf16 v[92:95], v[40:43], v[76:79], 0
    v_mfma_f32_16x16x32_bf16 v[96:99], v[56:59], v[76:79], 0
    v_mfma_f32_16x16x32_bf16 v[92:95], v[44:47], v[80:83], v[92:95]
    v_mfma_f32_16x16x32_bf16 v[96:99], v[60:63], v[80:83], v[96:99]
    v_mfma_f32_16x16x32_bf16 v[92:95], v[48:51], v[84:87], v[92:95]
    v_mfma_f32_16x16x32_bf16 v[96:99], v[64:67], v[84:87], v[96:99]
    v_mfma_f32_16x16x32_bf16 v[92:95], v[52:55], v[88:91], v[92:95]
    v_mfma_f32_16x16x32_bf16 v[96:99], v[68:71], v[88:91], v[96:99]
    s_waitcnt lgkmcnt(3)
    v_mfma_f32_16x16x32_bf16 v[24:27], v[40:43], v[8:11], 0
    v_mfma_f32_16x16x32_bf16 v[28:31], v[56:59], v[8:11], 0
    s_waitcnt lgkmcnt(2)
    v_mfma_f32_16x16x32_bf16 v[24:27], v[44:47], v[12:15], v[24:27]
    v_mfma_f32_16x16x32_bf16 v[28:31], v[60:63], v[12:15], v[28:31]
    s_waitcnt lgkmcnt(1)
    v_mfma_f32_16x16x32_bf16 v[24:27], v[48:51], v[16:19], v[24:27]
    v_mfma_f32_16x16x32_bf16 v[28:31], v[64:67], v[16:19], v[28:31]
    s_waitcnt lgkmcnt(0)
    v_mfma_f32_16x16x32_bf16 v[24:27], v[52:55], v[20:23], v[24:27]
    v_mfma_f32_16x16x32_bf16 v[28:31], v[68:71], v[20:23], v[28:31]
    s_mov_b64 exec, s[92:93]
    ds_write_b128 v124, v[92:95] offset:5120
    ds_write_b128 v124, v[96:99] offset:5184
    s_nop 3
    ds_write_b128 v124, v[24:27] offset:9216
    ds_write_b128 v124, v[28:31] offset:9280
    s_mov_b64 exec, -1
    s_waitcnt lgkmcnt(0)
    s_barrier
    s_mov_b32 s14, 0
    s_mov_b64 s[64:65], -1
    s_mov_b64 s[66:67], -1
    s_mov_b64 s[68:69], -1
    s_mov_b64 s[70:71], -1
L_poll_18:
    s_mov_b64 exec, s[64:65]
    buffer_load_dwordx4 v[8:11], v113, s[48:51], s84 offen sc1
    s_mov_b64 exec, s[66:67]
    buffer_load_dwordx4 v[12:15], v113, s[48:51], s85 offen sc1
    s_mov_b64 exec, s[68:69]
    buffer_load_dwordx4 v[16:19], v113, s[48:51], s86 offen sc1
    s_mov_b64 exec, s[70:71]
    buffer_load_dwordx4 v[20:23], v113, s[48:51], s87 offen sc1
    s_add_u32 s14, s14, 1
    s_cmp_gt_u32 s14, 1048576
    s_cbranch_scc1 L_end
    s_waitcnt vmcnt(3)
    s_mov_b64 exec, s[64:65]
    v_max3_u32 v6, v8, v9, v10
    v_max_u32 v6, v6, v11
    v_cmp_eq_u32 s[64:65], -1, v6
    s_waitcnt vmcnt(2)
    s_mov_b64 exec, s[66:67]
    v_max3_u32 v6, v12, v13, v14
    v_max_u32 v6, v6, v15
    v_cmp_eq_u32 s[66:67], -1, v6
    s_waitcnt vmcnt(1)
    s_mov_b64 exec, s[68:69]
    v_max3_u32 v6, v16, v17, v18
    v_max_u32 v6, v6, v19
    v_cmp_eq_u32 s[68:69], -1, v6
    s_waitcnt vmcnt(0)
    s_mov_b64 exec, s[70:71]
    v_max3_u32 v6, v20, v21, v22
    v_max_u32 v6, v6, v23
    v_cmp_eq_u32 s[70:71], -1, v6
    s_or_b64 s[46:47], s[64:65], s[66:67]
    s_or_b64 s[46:47], s[46:47], s[68:69]
    s_or_b64 s[46:47], s[46:47], s[70:71]
    s_cbranch_scc1 L_poll_18
    s_mov_b64 exec, -1
    v_pk_add_f32 v[8:9], v[8:9], v[12:13]
    v_pk_add_f32 v[10:11], v[10:11], v[14:15]
    v_pk_add_f32 v[16:17], v[16:17], v[20:21]
    v_pk_add_f32 v[18:19], v[18:19], v[22:23]
    v_pk_add_f32 v[8:9], v[8:9], v[16:17]
    v_pk_add_f32 v[10:11], v[10:11], v[18:19]
    s_nop 1
    v_permlane32_swap_b32 v8, v10
    v_permlane32_swap_b32 v9, v11
    v_pk_add_f32 v[8:9], v[8:9], v[10:11]
    v_pk_fma_f32 v[8:9], v[100:101], v[8:9], v[114:115]
    v_cvt_pk_bf16_f32 v6, v8, v9
    v_lshlrev_b32 v8, 16, v6
    v_and_b32 v9, 0xffff0000, v6
    v_readfirstlane_b32 s15, v8
    s_nop 1
    v_subrev_f32 v10, s15, v8
    v_subrev_f32 v11, s15, v9
    v_pk_mul_f32 v[12:13], v[10:11], v[104:105]
    v_cvt_pk_bf16_f32 v12, v12, v13
    ds_write_b32 v122, v12
    ds_read_b128 v[76:79], v116
    ds_read_b128 v[80:83], v117
    ds_read_b128 v[84:87], v118
    ds_read_b128 v[88:91], v119
    s_cmp_eq_u32 s62, 0
    s_cbranch_scc1 L_F1s
    s_waitcnt lgkmcnt(3)
    v_mfma_f32_16x16x32_bf16 v[92:95], v[40:43], v[76:79], 0
    v_mfma_f32_16x16x32_bf16 v[96:99], v[56:59], v[76:79], 0
    s_waitcnt lgkmcnt(2)
    v_mfma_f32_16x16x32_bf16 v[92:95], v[44:47], v[80:83], v[92:95]
    v_mfma_f32_16x16x32_bf16 v[96:99], v[60:63], v[80:83], v[96:99]
    s_waitcnt lgkmcnt(1)
    v_mfma_f32_16x16x32_bf16 v[92:95], v[48:51], v[84:87], v[92:95]
    v_mfma_f32_16x16x32_bf16 v[96:99], v[64:67], v[84:87], v[96:99]
    s_waitcnt lgkmcnt(0)
    v_mfma_f32_16x16x32_bf16 v[92:95], v[52:55], v[88:91], v[92:95]
    v_mfma_f32_16x16x32_bf16 v[96:99], v[68:71], v[88:91], v[96:99]
    s_nop 7
    s_branch L_F1w
L_F1s:
    v_add_f32 v16, v10, v11
    v_mul_f32 v17, v10, v10
    v_fmac_f32 v17, v11, v11
    v_mov_b32 v18, s15
    v_add_f32_dpp v16, v16, v16 quad_perm:[1,0,3,2] row_mask:0xf bank_mask:0xf
    v_add_f32_dpp v17, v17, v17 quad_perm:[1,0,3,2] row_mask:0xf bank_mask:0xf
    s_nop 0
    v_add_f32_dpp v16, v16, v16 quad_perm:[2,3,0,1] row_mask:0xf bank_mask:0xf
    v_add_f32_dpp v17, v17, v17 quad_perm:[2,3,0,1] row_mask:0xf bank_mask:0xf
    s_nop 0
    v_add_f32_dpp v16, v16, v16 row_half_mirror row_mask:0xf bank_mask:0xf
    v_add_f32_dpp v17, v17, v17 row_half_mirror row_mask:0xf bank_mask:0xf
    s_nop 0
    v_add_f32_dpp v16, v16, v16 row_mirror row_mask:0xf bank_mask:0xf
    v_add_f32_dpp v17, v17, v17 row_mirror row_mask:0xf bank_mask:0xf
    s_waitcnt lgkmcnt(3)
    v_mfma_f32_16x16x32_bf16 v[92:95], v[40:43], v[76:79], 0
    v_mov_b32 v20, v16
    v_mov_b32 v21, v17
    v_mfma_f32_16x16x32_bf16 v[96:99], v[56:59], v[76:79], 0
    v_permlane16_swap_b32 v16, v20
    v_permlane16_swap_b32 v17, v21
    s_waitcnt lgkmcnt(2)
    v_mfma_f32_16x16x32_bf16 v[92:95], v[44:47], v[80:83], v[92:95]
    v_add_f32 v16, v16, v20
    v_add_f32 v17, v17, v21
    v_mfma_f32_16x16x32_bf16 v[96:99], v[60:63], v[80:83], v[96:99]
    v_mov_b32 v20, v16
    v_mov_b32 v21, v17
    s_waitcnt lgkmcnt(1)
    v_mfma_f32_16x16x32_bf16 v[92:95], v[48:51], v[84:87], v[92:95]
    v_permlane32_swap_b32 v16, v20
    v_permlane32_swap_b32 v17, v21
    v_mfma_f32_16x16x32_bf16 v[96:99], v[64:67], v[84:87], v[96:99]
    v_add_f32 v16, v16, v20
    v_add_f32 v17, v17, v21
    s_waitcnt lgkmcnt(0)
    v_mfma_f32_16x16x32_bf16 v[92:95], v[52:55], v[88:91], v[92:95]
    v_mul_f32 v20, 0x3c000000, v16
    v_fma_f32 v17, -v20, v16, v17
    v_mfma_f32_16x16x32_bf16 v[96:99], v[68:71], v[88:91], v[96:99]
    v_add_f32 v16, v18, v20
    ds_write_b128 v123, v[16:19]
    ds_write_b64 v121, v[8:9]
L_F1w:
    s_mov_b64 exec, s[92:93]
    s_nop 0
    ds_write_b128 v124, v[92:95]
    s_nop 1
    ds_write_b128 v124, v[96:99] offset:64
    s_mov_b64 exec, -1
    s_waitcnt lgkmcnt(0)
    s_barrier
    s_branch L_fin
L_F2:
    s_add_u32 s12, s12, s62
    s_mov_b32 s52, s32
    s_mov_b32 s53, s33
    s_mov_b32 s54, 0x1c0000
    s_mov_b32 s55, 0x20000
    v_lshlrev_b32 v5, 11, v2
    v_lshl_add_u32 v5, v1, 4, v5
    s_lshl_b32 s14, s12, 15
    s_lshl_b32 s15, s61, 8
    s_add_u32 s64, s14, s15
    s_add_u32 s65, s64, 8192
    s_add_u32 s66, s64, 16384
    s_add_u32 s67, s64, 24576
    buffer_load_dwordx4 v[8:11], v5, s[52:55], s64 offen
    buffer_load_dwordx4 v[12:15], v5, s[52:55], s65 offen
    buffer_load_dwordx4 v[16:19], v5, s[52:55], s66 offen
    buffer_load_dwordx4 v[20:23], v5, s[52:55], s67 offen
    buffer_load_dwordx4 v[24:27], v5, s[52:55], s64 offen offset:1024
    buffer_load_dwordx4 v[28:31], v5, s[52:55], s65 offen offset:1024
    buffer_load_dwordx4 v[32:35], v5, s[52:55], s66 offen offset:1024
    buffer_load_dwordx4 v[36:39], v5, s[52:55], s67 offen offset:1024
    s_mov_b32 s52, s30
    s_mov_b32 s53, s31
    s_mov_b32 s54, 0xe00
    s_mov_b32 s55, 0x20000
    v_and_b32 v5, 3, v0
    v_lshlrev_b32 v5, 3, v5
    v_bfe_u32 v4, v0, 2, 3
    v_add_u32 v5, v5, v4
    v_lshlrev_b32 v5, 1, v5
    s_lshl_b32 s15, s12, 6
    buffer_load_ushort v126, v5, s[52:55], s15 offen
    s_mov_b32 s52, s34
    s_mov_b32 s53, s35
    s_mov_b32 s54, 0x400
    s_mov_b32 s55, 0x20000
    v_and_b32 v3, 31, v0
    v_lshlrev_b32 v6, 1, v3
    s_lshl_b32 s15, s4, 1
    s_add_u32 s15, s15, s11
    s_lshl_b32 s15, s15, 6
    buffer_load_ushort v112, v6, s[52:55], s15 offen
    s_lshl_b32 s15, s62, 11
    s_add_u32 s15, s15, 114944
    v_lshl_add_u32 v123, v3, 2, s15
    v_lshrrev_b32 v4, 5, v0
    v_lshl_add_u32 v123, v4, 10, v123
    v_add_u32 v124, 5120, v123
    v_add_u32 v125, 9216, v123
    v_mov_b32 v115, 110592
    v_lshl_add_u32 v114, v4, 5, v115
    s_lshl_b32 s15, s3, 6
    s_add_u32 s15, s15, 119040
    v_lshl_add_u32 v122, v3, 1, s15
    v_lshl_add_u32 v4, v2, 4, s15
    v_mov_b32 v5, 108288
    s_mov_b32 vcc_lo, 0xf000f
    s_mov_b32 vcc_hi, 0xf000f
    v_cndmask_b32 v116, v5, v4, vcc
    s_mov_b32 vcc_lo, 0xf000f0
    s_mov_b32 vcc_hi, 0xf000f0
    v_cndmask_b32 v117, v5, v4, vcc
    s_mov_b32 vcc_lo, 0xf000f00
    s_mov_b32 vcc_hi, 0xf000f00
    v_cndmask_b32 v118, v5, v4, vcc
    s_mov_b32 vcc_lo, 0xf000f000
    s_mov_b32 vcc_hi, 0xf000f000
    v_cndmask_b32 v119, v5, v4, vcc
    v_mul_u32_u24 v121, 7168, v2
    v_bfe_u32 v5, v0, 2, 2
    v_lshl_add_u32 v121, v5, 4, v121
    v_and_b32 v5, 1, v0
    v_lshl_add_u32 v121, v5, 6, v121
    s_mul_i32 s63, s10, 114688
    s_add_u32 s63, s63, 0x30000
    s_mul_i32 s60, s61, 28672
    s_add_u32 s60, s60, s63
    s_lshl_b32 s15, s12, 7
    s_add_u32 s60, s60, s15
    v_lshlrev_b32 v3, 4, v0
    s_waitcnt vmcnt(0)
    v_perm_b32 v40, v12, v8, s6
    v_perm_b32 v44, v12, v8, s7
    v_perm_b32 v48, v13, v9, s6
    v_perm_b32 v52, v13, v9, s7
    v_perm_b32 v56, v14, v10, s6
    v_perm_b32 v60, v14, v10, s7
    v_perm_b32 v64, v15, v11, s6
    v_perm_b32 v68, v15, v11, s7
    v_perm_b32 v41, v20, v16, s6
    v_perm_b32 v45, v20, v16, s7
    v_perm_b32 v49, v21, v17, s6
    v_perm_b32 v53, v21, v17, s7
    v_perm_b32 v57, v22, v18, s6
    v_perm_b32 v61, v22, v18, s7
    v_perm_b32 v65, v23, v19, s6
    v_perm_b32 v69, v23, v19, s7
    v_perm_b32 v42, v28, v24, s6
    v_perm_b32 v46, v28, v24, s7
    v_perm_b32 v50, v29, v25, s6
    v_perm_b32 v54, v29, v25, s7
    v_perm_b32 v58, v30, v26, s6
    v_perm_b32 v62, v30, v26, s7
    v_perm_b32 v66, v31, v27, s6
    v_perm_b32 v70, v31, v27, s7
    v_perm_b32 v43, v36, v32, s6
    v_perm_b32 v47, v36, v32, s7
    v_perm_b32 v51, v37, v33, s6
    v_perm_b32 v55, v37, v33, s7
    v_perm_b32 v59, v38, v34, s6
    v_perm_b32 v63, v38, v34, s7
    v_perm_b32 v67, v39, v35, s6
    v_perm_b32 v71, v39, v35, s7
    v_lshlrev_b32 v126, 16, v126
    s_cmp_lg_u32 s5, 8
    s_cbranch_scc1 L_F2r
    s_cmp_lg_u32 s3, 5
    s_cbranch_scc1 L_F2r
    s_mul_i32 s15, s4, 49152
    s_add_u32 s15, s15, 0xa0808
    v_mul_u32_u24 v5, 2176, v0
    s_mov_b32 s14, 0
    v_mov_b32 v72, s8
    v_mov_b32 v73, s9
    v_mov_b32 v74, 0
    s_mov_b64 exec, 0xfffff
L_F2k:
    buffer_load_dwordx2 v[76:77], v5, s[48:51], s15 offen sc1
    s_add_u32 s14, s14, 1
    s_sleep 1
    s_waitcnt vmcnt(0)
    v_cmp_eq_u64 vcc, s[8:9], v[76:77]
    s_cmp_ge_u32 s14, 64
    s_cselect_b32 s13, 1, vcc_lo
    s_cmp_eq_u32 s13, 0
    s_cbranch_scc1 L_F2k
    s_add_u32 s15, s15, 41464
    v_lshlrev_b32 v5, 9, v0
    s_mov_b64 exec, 0xff
L_F2l:
    buffer_load_dword v6, v5, s[48:51], s15 offen sc1
    s_add_u32 s14, s14, 1
    s_waitcnt vmcnt(0)
    v_cmp_ne_u32 vcc, -1, v6
    s_cmp_ge_u32 s14, 64
    s_cselect_b32 s13, 1, vcc_lo
    s_cmp_eq_u32 s13, 0
    s_cbranch_scc1 L_F2l
    s_lshl_b32 s15, s4, 8
    s_add_u32 s15, s15, 0x1f0000
    s_mov_b64 exec, 1
    buffer_store_dwordx2 v[72:73], v74, s[48:51], s15 offen sc1
    s_mov_b64 exec, -1
L_F2r:
    s_cmp_lg_u32 s3, 4
    s_cbranch_scc1 L_F2g
    s_mov_b32 s15, 0x1f0000
    v_lshlrev_b32 v5, 8, v0
    s_mov_b32 s14, 0
    s_mov_b32 exec_lo, 0xff
    s_mov_b32 exec_hi, 0x0
L_gate_19:
    s_sleep 1
    buffer_load_dwordx2 v[72:73], v5, s[48:51], s15 offen sc1
    s_add_u32 s14, s14, 1
    s_cmp_gt_u32 s14, 1048576
    s_cbranch_scc1 L_end
    s_waitcnt vmcnt(0)
    v_cmp_eq_u64 vcc, s[8:9], v[72:73]
    s_nop 0
    s_bcnt1_i32_b64 s13, vcc
    s_cmp_lt_u32 s13, 8
    s_cbranch_scc1 L_gate_19
    s_mov_b64 exec, -1
L_F2g:
    s_barrier
    ds_read2_b32 v[72:73], v124 offset0:0 offset1:32
    ds_read2_b32 v[74:75], v124 offset0:64 offset1:96
    ds_read2_b32 v[76:77], v124 offset0:128 offset1:160
    ds_read2_b32 v[78:79], v124 offset0:192 offset1:224
    ds_read2_b32 v[80:81], v125 offset0:0 offset1:32
    ds_read2_b32 v[82:83], v125 offset0:64 offset1:96
    ds_read2_b32 v[84:85], v125 offset0:128 offset1:160
    ds_read2_b32 v[86:87], v125 offset0:192 offset1:224
    s_waitcnt lgkmcnt(0)
    v_pk_add_f32 v[72:73], v[72:73], v[74:75]
    v_pk_add_f32 v[76:77], v[76:77], v[78:79]
    v_add_f32 v110, v72, v73
    v_add_f32 v111, v76, v77
    v_pk_add_f32 v[80:81], v[80:81], v[82:83]
    v_pk_add_f32 v[84:85], v[84:85], v[86:87]
    v_pk_add_f32 v[80:81], v[80:81], v[84:85]
    v_add_f32 v80, v80, v81
    v_mov_b32 v81, v80
    s_nop 1
    v_permlane32_swap_b32 v80, v81
    v_add_f32 v80, v80, v81
    v_add_f32 v126, v126, v80
    s_mov_b32 vcc_lo, 0xaaaaaaaa
    s_mov_b32 vcc_hi, 0xaaaaaaaa
    s_barrier
    ds_read_b64 v[8:9], v115 offset:0
    ds_read_b64 v[10:11], v115 offset:16
    ds_read_b64 v[12:13], v115 offset:32
    ds_read_b64 v[14:15], v115 offset:48
    ds_read2_b32 v[16:17], v114 offset0:2 offset1:6
    ds_read2_b32 v[72:73], v123 offset0:0 offset1:32
    ds_read2_b32 v[74:75], v123 offset0:64 offset1:96
    ds_read2_b32 v[76:77], v123 offset0:128 offset1:160
    ds_read2_b32 v[78:79], v123 offset0:192 offset1:224
    s_waitcnt lgkmcnt(5)
    v_pk_add_f32 v[18:19], v[8:9], v[10:11]
    v_pk_add_f32 v[20:21], v[12:13], v[14:15]
    v_pk_add_f32 v[18:19], v[18:19], v[20:21]
    v_mul_f32 v18, 0x3e800000, v18
    v_mov_b32 v22, 0x3727c5ac
    v_fmac_f32 v22, 0x3b000000, v19
    v_sub_f32 v8, v8, v18
    v_sub_f32 v10, v10, v18
    v_sub_f32 v12, v12, v18
    v_sub_f32 v14, v14, v18
    v_mul_f32 v9, v8, v8
    v_mul_f32 v11, v10, v10
    v_fmac_f32 v9, v12, v12
    v_fmac_f32 v11, v14, v14
    v_add_f32 v9, v9, v11
    v_fmac_f32 v22, 0x3e800000, v9
    v_max_f32 v22, 0x3727c5ac, v22
    v_rsq_f32 v22, v22
    v_cvt_pk_bf16_f32 v18, v18, v18
    v_lshlrev_b32 v18, 16, v18
    s_waitcnt lgkmcnt(0)
    v_sub_f32 v16, v16, v18
    v_sub_f32 v17, v17, v18
    v_pk_add_f32 v[72:73], v[72:73], v[74:75]
    v_pk_add_f32 v[76:77], v[76:77], v[78:79]
    v_pk_fma_f32 v[72:73], v[16:17], v[110:111], v[72:73]
    v_pk_add_f32 v[72:73], v[72:73], v[76:77]
    v_add_f32 v72, v72, v73
    v_mov_b32 v73, v72
    s_nop 1
    v_permlane32_swap_b32 v72, v73
    v_add_f32 v72, v72, v73
    v_fma_f32 v72, v72, v22, v126
    v_max_f32 v72, 0, v72
    v_mul_f32 v72, v72, v72
    v_cvt_pk_bf16_f32 v72, v72, v72
    ds_write_b16 v122, v72
    ds_read_b128 v[76:79], v116
    ds_read_b128 v[80:83], v117
    ds_read_b128 v[84:87], v118
    ds_read_b128 v[88:91], v119
    s_waitcnt lgkmcnt(3)
    v_mfma_f32_16x16x32_bf16 v[92:95], v[40:43], v[76:79], 0
    v_mfma_f32_16x16x32_bf16 v[96:99], v[56:59], v[76:79], 0
    s_waitcnt lgkmcnt(2)
    v_mfma_f32_16x16x32_bf16 v[92:95], v[44:47], v[80:83], v[92:95]
    v_mfma_f32_16x16x32_bf16 v[96:99], v[60:63], v[80:83], v[96:99]
    s_waitcnt lgkmcnt(1)
    v_mfma_f32_16x16x32_bf16 v[92:95], v[48:51], v[84:87], v[92:95]
    v_mfma_f32_16x16x32_bf16 v[96:99], v[64:67], v[84:87], v[96:99]
    s_waitcnt lgkmcnt(0)
    v_mfma_f32_16x16x32_bf16 v[92:95], v[52:55], v[88:91], v[92:95]
    v_mfma_f32_16x16x32_bf16 v[96:99], v[68:71], v[88:91], v[96:99]
    s_mov_b32 exec_lo, 0x33333333
    s_mov_b32 exec_hi, 0x33333333
    s_nop 5
    v_cndmask_b32 v92, v92, v96, vcc
    v_cndmask_b32 v93, v93, v97, vcc
    v_cndmask_b32 v94, v94, v98, vcc
    v_cndmask_b32 v95, v95, v99, vcc
    v_min_u32 v92, -2, v92
    v_min_u32 v93, -2, v93
    v_min_u32 v94, -2, v94
    v_min_u32 v95, -2, v95
    buffer_store_dwordx4 v[92:95], v121, s[48:51], s60 offen sc1
    s_mov_b64 exec, -1
    s_cmp_lg_u32 s3, 4
    s_cbranch_scc1 L_fin
    s_cmp_ge_u32 s11, 2
    s_cbranch_scc1 L_fin
    s_lshl_b32 s60, s4, 1
    s_add_u32 s60, s60, s11
    s_mov_b32 s56, s40
    s_mov_b32 s57, s41
    s_mov_b32 s58, 0x1000
    s_mov_b32 s59, 0x20000
    v_and_b32 v4, 31, v0
    v_lshlrev_b32 v4, 1, v4
    s_lshl_b32 s15, s60, 6
    v_lshlrev_b32 v40, 16, v112
    v_and_b32 v6, 3, v0
    v_lshlrev_b32 v6, 4, v6
    v_bfe_u32 v5, v0, 2, 2
    v_lshl_add_u32 v6, v5, 2, v6
    v_bfe_u32 v5, v0, 4, 1
    v_lshl_add_u32 v6, v5, 6, v6
    s_lshl_b32 s14, s60, 7
    s_add_u32 s14, s14, 110848
    v_add_u32 v6, s14, v6
    ds_read_b32 v41, v6
    ds_read_b32 v42, v6 offset:2048
    s_lshl_b32 s14, s10, 10
    s_add_u32 s61, s15, s14
    s_mul_i32 s14, s60, 7168
    s_add_u32 s80, s14, s63
    s_add_u32 s81, s80, 4096
    s_waitcnt vmcnt(0) lgkmcnt(0)
    v_fma_f32 v41, v42, v40, v41
    s_mov_b32 s14, 0
    s_mov_b64 s[64:65], -1
    s_mov_b64 s[66:67], -1
    s_mov_b64 s[68:69], -1
    s_mov_b64 s[70:71], -1
    s_mov_b64 s[72:73], -1
    s_mov_b64 s[74:75], -1
    s_mov_b64 s[76:77], -1
L_poll_20:
    s_mov_b64 exec, s[64:65]
    buffer_load_dwordx4 v[8:11], v3, s[48:51], s80 offen sc1
    s_mov_b64 exec, s[66:67]
    buffer_load_dwordx4 v[12:15], v3, s[48:51], s80 offen offset:1024 sc1
    s_mov_b64 exec, s[68:69]
    buffer_load_dwordx4 v[16:19], v3, s[48:51], s80 offen offset:2048 sc1
    s_mov_b64 exec, s[70:71]
    buffer_load_dwordx4 v[20:23], v3, s[48:51], s80 offen offset:3072 sc1
    s_mov_b64 exec, s[72:73]
    buffer_load_dwordx4 v[24:27], v3, s[48:51], s81 offen sc1
    s_mov_b64 exec, s[74:75]
    buffer_load_dwordx4 v[28:31], v3, s[48:51], s81 offen offset:1024 sc1
    s_mov_b64 exec, s[76:77]
    buffer_load_dwordx4 v[32:35], v3, s[48:51], s81 offen offset:2048 sc1
    s_add_u32 s14, s14, 1
    s_cmp_gt_u32 s14, 1048576
    s_cbranch_scc1 L_end
    s_waitcnt vmcnt(6)
    s_mov_b64 exec, s[64:65]
    v_max3_u32 v43, v8, v9, v10
    v_max_u32 v43, v43, v11
    v_cmp_eq_u32 s[64:65], -1, v43
    s_waitcnt vmcnt(5)
    s_mov_b64 exec, s[66:67]
    v_max3_u32 v43, v12, v13, v14
    v_max_u32 v43, v43, v15
    v_cmp_eq_u32 s[66:67], -1, v43
    s_waitcnt vmcnt(4)
    s_mov_b64 exec, s[68:69]
    v_max3_u32 v43, v16, v17, v18
    v_max_u32 v43, v43, v19
    v_cmp_eq_u32 s[68:69], -1, v43
    s_waitcnt vmcnt(3)
    s_mov_b64 exec, s[70:71]
    v_max3_u32 v43, v20, v21, v22
    v_max_u32 v43, v43, v23
    v_cmp_eq_u32 s[70:71], -1, v43
    s_waitcnt vmcnt(2)
    s_mov_b64 exec, s[72:73]
    v_max3_u32 v43, v24, v25, v26
    v_max_u32 v43, v43, v27
    v_cmp_eq_u32 s[72:73], -1, v43
    s_waitcnt vmcnt(1)
    s_mov_b64 exec, s[74:75]
    v_max3_u32 v43, v28, v29, v30
    v_max_u32 v43, v43, v31
    v_cmp_eq_u32 s[74:75], -1, v43
    s_waitcnt vmcnt(0)
    s_mov_b64 exec, s[76:77]
    v_max3_u32 v43, v32, v33, v34
    v_max_u32 v43, v43, v35
    v_cmp_eq_u32 s[76:77], -1, v43
    s_or_b64 s[46:47], s[64:65], s[66:67]
    s_or_b64 s[46:47], s[46:47], s[68:69]
    s_or_b64 s[46:47], s[46:47], s[70:71]
    s_or_b64 s[46:47], s[46:47], s[72:73]
    s_or_b64 s[46:47], s[46:47], s[74:75]
    s_or_b64 s[46:47], s[46:47], s[76:77]
    s_cbranch_scc1 L_poll_20
    s_mov_b64 exec, -1
    v_pk_add_f32 v[8:9], v[8:9], v[12:13]
    v_pk_add_f32 v[10:11], v[10:11], v[14:15]
    v_pk_add_f32 v[16:17], v[16:17], v[20:21]
    v_pk_add_f32 v[18:19], v[18:19], v[22:23]
    v_pk_add_f32 v[24:25], v[24:25], v[28:29]
    v_pk_add_f32 v[26:27], v[26:27], v[30:31]
    v_pk_add_f32 v[8:9], v[8:9], v[32:33]
    v_pk_add_f32 v[10:11], v[10:11], v[34:35]
    v_pk_add_f32 v[16:17], v[16:17], v[24:25]
    v_pk_add_f32 v[18:19], v[18:19], v[26:27]
    v_pk_add_f32 v[8:9], v[8:9], v[16:17]
    v_pk_add_f32 v[10:11], v[10:11], v[18:19]
    s_nop 0
    v_add_f32_dpp v8, v8, v8 row_ror:8 row_mask:0xf bank_mask:0xf
    v_add_f32_dpp v9, v9, v9 row_ror:8 row_mask:0xf bank_mask:0xf
    v_add_f32_dpp v10, v10, v10 row_ror:8 row_mask:0xf bank_mask:0xf
    v_add_f32_dpp v11, v11, v11 row_ror:8 row_mask:0xf bank_mask:0xf
    s_mov_b32 vcc_lo, 0xff00ff00
    s_mov_b32 vcc_hi, 0xff00ff00
    v_cndmask_b32 v8, v8, v9, vcc
    v_cndmask_b32 v10, v10, v11, vcc
    s_nop 1
    v_permlane16_swap_b32 v8, v10
    v_add_f32 v8, v8, v10
    v_mov_b32 v9, v8
    s_nop 1
    v_permlane32_swap_b32 v8, v9
    v_add_f32 v8, v8, v9
    v_fma_f32 v8, v42, v8, v41
    v_cvt_pk_bf16_f32 v8, v8, v8
    s_mov_b32 exec_lo, 0xffffffff
    s_mov_b32 exec_hi, 0x0
    buffer_store_short v8, v4, s[56:59], s61 offen
    s_mov_b64 exec, -1
    s_or_b32 s14, s60, s10
    s_cbranch_scc1 L_fin
    v_mov_b32 v10, s8
    v_mov_b32 v11, s9
    v_mov_b32 v12, 0
    s_mov_b64 exec, 1
    buffer_store_dwordx2 v[10:11], v12, s[48:51], 0 offen sc1
L_fin:
L_end:
    s_endpgm
L_codeend:
.section .rodata,"a"
.p2align 6
.amdhsa_kernel adaLN_cond__sliding_block_cached__dense_activation_squared_relu__decode_kernel
.amdhsa_next_free_vgpr 128
.amdhsa_next_free_sgpr 102
.amdhsa_accum_offset 128
.amdhsa_group_segment_fixed_size 0
.amdhsa_kernarg_size 120
.amdhsa_user_sgpr_count 2
.amdhsa_user_sgpr_kernarg_segment_ptr 1
.amdhsa_system_sgpr_workgroup_id_x 1
.amdhsa_float_denorm_mode_32 3
.end_amdhsa_kernel
```
